```python
import torch

def _softmax(x, axis=-1):
    return torch.softmax(x, dim=axis)
def _gelu(x):
    return torch.nn.functional.gelu(x, approximate="tanh")
def _silu(x):
    return torch.nn.functional.silu(x)
def _sigmoid(x):
    return torch.sigmoid(x)
def _layernorm(x, axis=-1, eps=1e-5):
    m = x.mean(dim=axis, keepdim=True)
    v = x.var(dim=axis, keepdim=True, unbiased=False)
    return (x - m) / torch.sqrt(v + eps)
def _scatter_add(tgt, idx, src, axis=0):
    return tgt.clone().index_add_(axis, idx, src)
def _segment_sum(src, seg, n):
    out = torch.zeros((n,) + src.shape[1:], dtype=src.dtype)
    return out.index_add_(0, seg, src)
def _pad(x, pw):
    flat = tuple(v for pair in reversed(pw) for v in pair)
    return torch.nn.functional.pad(x, flat)

kernel_name = 'parallel_sum__sliding_block_cached__glu_gated_swiglu__decode'

def setup_inputs():

    _w = (lambda a: (lambda t: t.to(torch.bfloat16) if t.is_floating_point() else t)(torch.as_tensor(a)))
    def _A_setup():
        B, Sq, D = 1, 1, 640
        Hq, Hkv, Sk, Dh = 32, 32, 32768, 192
        assert Hq % Hkv == 0, (Hq, Hkv)
        return {
            "x": _w((lambda *s: torch.randn(*s, dtype=torch.bfloat16) * 0.05)(B, Sq, D)),
            "k_cache": _w((lambda *s: torch.randn(*s, dtype=torch.bfloat16) * 1.6)(B, Hkv, Sk, Dh)),
            "v_cache": _w((lambda *s: torch.randn(*s, dtype=torch.bfloat16) * 0.8)(B, Hkv, Sk, Dh)),
            "wq": _w((lambda *s: torch.randn(*s, dtype=torch.bfloat16) * 1.6)(D, Hq * Dh) * (D ** -0.5)),
            "wo": _w((lambda *s: torch.randn(*s, dtype=torch.bfloat16) * 0.8)(Hq * Dh, D) * ((Hq * Dh) ** -0.5)),
        }
    _A_in = _A_setup()

    def _B_setup():
        B, S, D, F = 1, 1, 640, 1536
        return {
            "x": _w((lambda *s: torch.randn(*s, dtype=torch.bfloat16) * 0.05)(B, S, D)),
            "w1": _w((lambda *s: torch.randn(*s, dtype=torch.bfloat16) * 0.4)(D, F) * (2.0 / D) ** 0.5),
            "w3": _w((lambda *s: torch.randn(*s, dtype=torch.bfloat16) * 0.4)(D, F) * (2.0 / D) ** 0.5),
            "w2": _w((lambda *s: torch.randn(*s, dtype=torch.bfloat16) * 0.4)(F, D) * (2.0 / F) ** 0.5),
        }
    _B_in = _B_setup()

    return {
        "A_x": _A_in["x"],
        "A_k_cache": _A_in["k_cache"],
        "A_v_cache": _A_in["v_cache"],
        "A_wq": _A_in["wq"],
        "A_wo": _A_in["wo"],
        "B_x": _B_in["x"],
        "B_w1": _B_in["w1"],
        "B_w3": _B_in["w3"],
        "B_w2": _B_in["w2"],
    }

def reference(A_x, A_k_cache, A_v_cache, A_wq, A_wo, B_x, B_w1, B_w3, B_w2):
    def _A_ref(x, k_cache, v_cache, wq, wo):
        B, Sq, D = x.shape
        Hq, Dh = 32, 192
        Hkv, Sk = k_cache.shape[1], k_cache.shape[2]
        W = min(4096, max(256, Sk // 4))
        rep = Hq // Hkv
        q = (lambda x, *d: x.permute(*d))((x @ wq).reshape(B, Sq, Hq, Dh), 0, 2, 1, 3)
        k = (lambda x, n, axis: torch.repeat_interleave(x, n, dim=axis))(k_cache[:, :, Sk - W:, :], rep, axis=1)
        v = (lambda x, n, axis: torch.repeat_interleave(x, n, dim=axis))(v_cache[:, :, Sk - W:, :], rep, axis=1)
        scores = torch.einsum("bhqd,bhkd->bhqk", q, k) * (Dh ** -0.5)
        p = _softmax(scores, axis=-1)
        o = torch.einsum("bhqk,bhkd->bhqd", p, v)
        return (lambda x, *d: x.permute(*d))(o, 0, 2, 1, 3).reshape(B, Sq, Hq * Dh) @ wo

    def _B_ref(x, w1, w3, w2):
        gate = torch.einsum("bsd,df->bsf", x, w1)
        up = torch.einsum("bsd,df->bsf", x, w3)
        h = _silu(gate) * up
        out = torch.einsum("bsf,fd->bsd", h, w2)
        return out

    x = A_x
    xn = _layernorm(x, axis=-1)
    return x + _A_ref(xn, A_k_cache, A_v_cache, A_wq, A_wo) + _B_ref(xn, B_w1, B_w3, B_w2)
```

```asm
; @launch grid=(256,1,1) block=(512,1,1) lds=17408
.amdgcn_target "amdgcn-amd-amdhsa--gfx950"
.text
.globl parallel_sum__sliding_block_cached__glu_gated_swiglu__decode_kernel
.p2align 8
.type parallel_sum__sliding_block_cached__glu_gated_swiglu__decode_kernel,@function
parallel_sum__sliding_block_cached__glu_gated_swiglu__decode_kernel:
    s_cmp_ge_u32 s2, 256
    s_cbranch_scc1 L_end
    s_load_dwordx16 s[52:67], s[0:1], 0
    s_load_dwordx8 s[68:75], s[0:1], 64
    v_lshrrev_b32 v15, 6, v0
    v_and_b32 v2, 63, v0
    v_readfirstlane_b32 s3, v15
    s_and_b32 s4, s2, 31
    s_lshr_b32 s5, s2, 5
    s_lshr_b32 s6, s5, 1
    s_and_b32 s7, s5, 1
    v_lshrrev_b32 v15, 3, v2
    v_and_b32 v3, 7, v2
    v_lshlrev_b32 v3, 4, v3
    v_mul_u32_u24 v1, 384, v15
    v_add_u32 v1, v1, v3
    v_lshlrev_b32 v6, 4, v2
    s_mul_i32 s76, s4, 12582912
    s_mul_i32 s77, s5, 196608
    s_add_u32 s76, s76, s77
    s_add_u32 s76, s76, 11010048
    s_cmp_eq_u32 s3, 7
    s_cbranch_scc1 L_aux
    s_lshr_b32 s77, s2, 3
    s_add_u32 s77, s77, s2
    s_mul_i32 s87, s77, 57
    s_lshr_b32 s87, s87, 9
    s_mul_i32 s87, s87, 9
    s_sub_u32 s77, s77, s87
    s_mul_i32 s87, s3, 3072
    s_add_u32 s76, s76, s87
    s_add_u32 s78, s77, 0
    s_sub_u32 s87, s78, 9
    s_cmp_ge_u32 s78, 9
    s_cselect_b32 s78, s87, s78
    s_mul_i32 s78, s78, 21504
    s_add_u32 s78, s78, s76
    s_add_u32 s79, s77, 1
    s_sub_u32 s87, s79, 9
    s_cmp_ge_u32 s79, 9
    s_cselect_b32 s79, s87, s79
    s_mul_i32 s79, s79, 21504
    s_add_u32 s79, s79, s76
    s_add_u32 s80, s77, 2
    s_sub_u32 s87, s80, 9
    s_cmp_ge_u32 s80, 9
    s_cselect_b32 s80, s87, s80
    s_mul_i32 s80, s80, 21504
    s_add_u32 s80, s80, s76
    s_add_u32 s81, s77, 3
    s_sub_u32 s87, s81, 9
    s_cmp_ge_u32 s81, 9
    s_cselect_b32 s81, s87, s81
    s_mul_i32 s81, s81, 21504
    s_add_u32 s81, s81, s76
    s_add_u32 s82, s77, 4
    s_sub_u32 s87, s82, 9
    s_cmp_ge_u32 s82, 9
    s_cselect_b32 s82, s87, s82
    s_mul_i32 s82, s82, 21504
    s_add_u32 s82, s82, s76
    s_add_u32 s83, s77, 5
    s_sub_u32 s87, s83, 9
    s_cmp_ge_u32 s83, 9
    s_cselect_b32 s83, s87, s83
    s_mul_i32 s83, s83, 21504
    s_add_u32 s83, s83, s76
    s_add_u32 s84, s77, 6
    s_sub_u32 s87, s84, 9
    s_cmp_ge_u32 s84, 9
    s_cselect_b32 s84, s87, s84
    s_mul_i32 s84, s84, 21504
    s_add_u32 s84, s84, s76
    s_add_u32 s85, s77, 7
    s_sub_u32 s87, s85, 9
    s_cmp_ge_u32 s85, 9
    s_cselect_b32 s85, s87, s85
    s_mul_i32 s85, s85, 21504
    s_add_u32 s85, s85, s76
    s_add_u32 s86, s77, 8
    s_sub_u32 s87, s86, 9
    s_cmp_ge_u32 s86, 9
    s_cselect_b32 s86, s87, s86
    s_mul_i32 s86, s86, 21504
    s_add_u32 s86, s86, s76
    s_cmp_lt_u32 s3, 4
    s_cbranch_scc1 L_noprio
    s_setprio 1
L_noprio:
    v_lshrrev_b32 v15, 3, v2
    v_mul_u32_u24 v4, 7680, v15
    v_add_u32 v4, v4, v3
    v_mul_u32_u24 v5, 2560, v15
    v_add_u32 v5, v5, v3
    v_lshlrev_b32 v9, 2, v15
    s_lshl_b32 s87, s6, 5
    v_add_u32 v9, s87, v9
    v_lshlrev_b32 v8, 4, v3
    v_mul_u32_u24 v7, 24, v15
    v_and_b32 v16, 16, v2
    v_lshl_add_u32 v11, v3, 1, v16
    v_lshrrev_b32 v15, 5, v2
    v_mul_u32_u24 v15, 768, v15
    s_mul_i32 s87, s3, 1536
    v_add3_u32 v14, v11, v15, s87
    s_waitcnt lgkmcnt(0)
    s_mov_b32 s8, s54
    s_mov_b32 s9, s55
    s_mov_b32 s10, 402653184
    s_mov_b32 s11, 0x00020000
    buffer_load_dwordx4 v[40:43], v1, s[8:11], s78 offen offset:0 nt
    buffer_load_dwordx4 v[44:47], v1, s[8:11], s78 offen offset:128 nt
    buffer_load_dwordx4 v[48:51], v1, s[8:11], s78 offen offset:256 nt
    buffer_load_dwordx4 v[52:55], v1, s[8:11], s79 offen offset:0 nt
    s_mov_b32 s12, s56
    s_mov_b32 s13, s57
    s_mov_b32 s14, 402653184
    s_mov_b32 s15, 0x00020000
    s_mov_b32 s16, s74
    s_mov_b32 s17, s75
    s_mov_b32 s18, 1610612736
    s_mov_b32 s19, 0x00020000
    s_mov_b32 s24, s60
    s_mov_b32 s25, s61
    s_mov_b32 s26, 7864320
    s_mov_b32 s27, 0x00020000
    s_mov_b32 s36, s68
    s_mov_b32 s37, s69
    s_mov_b32 s38, 1966080
    s_mov_b32 s39, 0x00020000
    s_mov_b32 s44, s70
    s_mov_b32 s45, s71
    s_mov_b32 s46, 1280
    s_mov_b32 s47, 0x00020000
    s_mov_b32 s48, s72
    s_mov_b32 s49, s73
    s_mov_b32 s50, 256
    s_mov_b32 s51, 0x00020000
    s_mov_b32 s40, s52
    s_mov_b32 s41, s53
    s_mov_b32 s42, 1280
    s_mov_b32 s43, 0x00020000
    s_mul_i32 s52, s4, 192
    s_mul_i32 s63, s6, 48
    s_add_u32 s52, s52, s63
    s_mul_i32 s52, s52, 1280
    s_mul_i32 s63, s7, 640
    s_add_u32 s52, s52, s63
    s_lshl_b32 s53, s4, 6
    s_lshl_b32 s62, s6, 4
    s_add_u32 s53, s53, s62
    s_mul_i32 s53, s53, 1280
    s_add_u32 s53, s53, s63
    s_cmp_lt_u32 s4, 24
    s_cselect_b32 s53, s53, 1073741824
    s_sub_u32 s62, s3, 1
    s_cmp_lt_u32 s62, 4
    s_cselect_b32 s62, s62, 8
    s_cmp_eq_u32 s3, 7
    s_cselect_b32 s62, 4, s62
    s_lshl_b32 s63, s62, 7
    s_cmp_lt_u32 s62, 5
    s_cselect_b32 s63, s63, 1073741824
    s_add_u32 s52, s52, s63
    s_add_u32 s53, s53, s63
    s_add_u32 s64, s52, 5120
    s_lshl_b32 s65, s62, 8
    s_lshl_b32 s54, s4, 13
    s_add_u32 s54, s54, 524288
    s_lshl_b32 s62, s6, 11
    s_add_u32 s55, s54, s62
    s_lshl_b32 s62, s5, 8
    s_add_u32 s56, s54, s62
    s_mul_i32 s57, s4, 10240
    s_add_u32 s57, s57, 2097152
    s_lshl_b32 s58, s4, 2
    s_add_u32 s58, s58, s6
    s_mul_i32 s58, s58, 2560
    s_mul_i32 s62, s7, 1280
    s_add_u32 s58, s58, s62
    s_add_u32 s58, s58, 2097152
    s_add_u32 s58, s58, s65
    s_mul_i32 s59, s4, 10240
    s_mul_i32 s62, s5, 1280
    s_add_u32 s59, s59, s62
    s_add_u32 s59, s59, 2097152
    s_barrier
    s_waitcnt vmcnt(3)
    buffer_load_dwordx4 v[56:59], v1, s[8:11], s79 offen offset:128 nt
    s_waitcnt vmcnt(3)
    buffer_load_dwordx4 v[60:63], v1, s[8:11], s79 offen offset:256 nt
    s_waitcnt vmcnt(3)
    buffer_load_dwordx4 v[64:67], v1, s[8:11], s80 offen offset:0 nt
    s_waitcnt vmcnt(3)
    buffer_load_dwordx4 v[68:71], v1, s[8:11], s80 offen offset:128 nt
    s_waitcnt vmcnt(3)
    buffer_load_dwordx4 v[72:75], v1, s[8:11], s80 offen offset:256 nt
    s_waitcnt vmcnt(3)
    buffer_load_dwordx4 v[76:79], v1, s[8:11], s81 offen offset:0 nt
    s_waitcnt vmcnt(3)
    buffer_load_dwordx4 v[80:83], v1, s[8:11], s81 offen offset:128 nt
    s_waitcnt vmcnt(3)
    buffer_load_dwordx4 v[84:87], v1, s[8:11], s81 offen offset:256 nt
    s_waitcnt vmcnt(3)
    buffer_load_dwordx4 v[88:91], v1, s[8:11], s82 offen offset:0 nt
    s_waitcnt vmcnt(3)
    buffer_load_dwordx4 v[92:95], v1, s[8:11], s82 offen offset:128 nt
    s_waitcnt vmcnt(3)
    buffer_load_dwordx4 v[96:99], v1, s[8:11], s82 offen offset:256 nt
    s_waitcnt vmcnt(3)
    buffer_load_dwordx4 v[100:103], v1, s[8:11], s83 offen offset:0 nt
    s_waitcnt vmcnt(3)
    buffer_load_dwordx4 v[104:107], v1, s[8:11], s83 offen offset:128 nt
    s_waitcnt vmcnt(3)
    buffer_load_dwordx4 v[108:111], v1, s[8:11], s83 offen offset:256 nt
    s_waitcnt vmcnt(3)
    buffer_load_dwordx4 v[112:115], v1, s[8:11], s84 offen offset:0 nt
    s_waitcnt vmcnt(3)
    buffer_load_dwordx4 v[116:119], v1, s[8:11], s84 offen offset:128 nt
    s_waitcnt vmcnt(3)
    buffer_load_dwordx4 v[120:123], v1, s[8:11], s84 offen offset:256 nt
    s_waitcnt vmcnt(3)
    buffer_load_dwordx4 v[124:127], v1, s[8:11], s85 offen offset:0 nt
    s_waitcnt vmcnt(3)
    buffer_load_dwordx4 v[128:131], v1, s[8:11], s85 offen offset:128 nt
    s_waitcnt vmcnt(3)
    buffer_load_dwordx4 v[132:135], v1, s[8:11], s85 offen offset:256 nt
    s_waitcnt vmcnt(3)
    buffer_load_dwordx4 v[136:139], v1, s[8:11], s86 offen offset:0 nt
    s_waitcnt vmcnt(3)
    buffer_load_dwordx4 v[140:143], v1, s[8:11], s86 offen offset:128 nt
    s_waitcnt vmcnt(3)
    buffer_load_dwordx4 v[144:147], v1, s[8:11], s86 offen offset:256 nt
    v_mov_b32 v15, 3328
    s_waitcnt vmcnt(3)
    buffer_load_dwordx4 v[148:151], v1, s[12:15], s78 offen offset:0 nt
    s_waitcnt vmcnt(3)
    buffer_load_dwordx4 v[152:155], v1, s[12:15], s78 offen offset:128 nt
    s_waitcnt vmcnt(3)
    buffer_load_dwordx4 v[156:159], v1, s[12:15], s78 offen offset:256 nt
    ds_read_b32 v16, v15
    s_waitcnt vmcnt(3)
    buffer_load_dwordx4 v[160:163], v1, s[12:15], s79 offen offset:0 nt
    s_waitcnt lgkmcnt(0)
    v_readfirstlane_b32 s66, v16
    s_cmp_lg_u32 s66, 0
    s_nop 3
    s_cbranch_scc1 L_cont4
    s_waitcnt vmcnt(3)
    buffer_load_dwordx4 v[164:167], v1, s[12:15], s79 offen offset:128 nt
    s_waitcnt vmcnt(3)
    buffer_load_dwordx4 v[168:171], v1, s[12:15], s79 offen offset:256 nt
    s_waitcnt vmcnt(3)
    buffer_load_dwordx4 v[172:175], v1, s[12:15], s80 offen offset:0 nt
    ds_read_b32 v16, v15
    s_waitcnt vmcnt(3)
    buffer_load_dwordx4 v[176:179], v1, s[12:15], s80 offen offset:128 nt
    s_waitcnt lgkmcnt(0)
    v_readfirstlane_b32 s66, v16
    s_cmp_lg_u32 s66, 0
    s_nop 3
    s_cbranch_scc1 L_cont8
    s_waitcnt vmcnt(3)
    buffer_load_dwordx4 v[180:183], v1, s[12:15], s80 offen offset:256 nt
    s_waitcnt vmcnt(3)
    buffer_load_dwordx4 v[184:187], v1, s[12:15], s81 offen offset:0 nt
    ds_read_b32 v16, v15
    s_waitcnt vmcnt(3)
    buffer_load_dwordx4 v[188:191], v1, s[12:15], s81 offen offset:128 nt
    s_waitcnt lgkmcnt(0)
    v_readfirstlane_b32 s66, v16
    s_cmp_lg_u32 s66, 0
    s_nop 3
    s_cbranch_scc1 L_cont11
    s_waitcnt vmcnt(3)
    buffer_load_dwordx4 v[192:195], v1, s[12:15], s81 offen offset:256 nt
    s_waitcnt vmcnt(3)
    buffer_load_dwordx4 v[196:199], v1, s[12:15], s82 offen offset:0 nt
    ds_read_b32 v16, v15
    s_waitcnt vmcnt(3)
    buffer_load_dwordx4 v[200:203], v1, s[12:15], s82 offen offset:128 nt
    s_waitcnt lgkmcnt(0)
    v_readfirstlane_b32 s66, v16
    s_cmp_lg_u32 s66, 0
    s_nop 3
    s_cbranch_scc1 L_cont14
    s_waitcnt vmcnt(3)
    buffer_load_dwordx4 v[204:207], v1, s[12:15], s82 offen offset:256 nt
    s_waitcnt vmcnt(3)
    buffer_load_dwordx4 v[208:211], v1, s[12:15], s83 offen offset:0 nt
    ds_read_b32 v16, v15
    s_waitcnt vmcnt(3)
    buffer_load_dwordx4 v[212:215], v1, s[12:15], s83 offen offset:128 nt
    s_waitcnt lgkmcnt(0)
    v_readfirstlane_b32 s66, v16
    s_cmp_lg_u32 s66, 0
    s_nop 3
    s_cbranch_scc1 L_cont17
    s_waitcnt vmcnt(3)
    buffer_load_dwordx4 v[216:219], v1, s[12:15], s83 offen offset:256 nt
    s_waitcnt vmcnt(3)
    buffer_load_dwordx4 v[220:223], v1, s[12:15], s84 offen offset:0 nt
    ds_read_b32 v16, v15
    s_waitcnt vmcnt(3)
    buffer_load_dwordx4 v[224:227], v1, s[12:15], s84 offen offset:128 nt
    s_waitcnt lgkmcnt(0)
    v_readfirstlane_b32 s66, v16
    s_cmp_lg_u32 s66, 0
    s_nop 3
    s_cbranch_scc1 L_cont20
    s_waitcnt vmcnt(3)
    buffer_load_dwordx4 v[228:231], v1, s[12:15], s84 offen offset:256 nt
    s_waitcnt vmcnt(3)
    buffer_load_dwordx4 v[232:235], v1, s[12:15], s85 offen offset:0 nt
    s_waitcnt vmcnt(3)
    buffer_load_dwordx4 v[236:239], v1, s[12:15], s85 offen offset:128 nt
    ds_read_b32 v16, v15
    s_waitcnt vmcnt(3)
    buffer_load_dwordx4 v[240:243], v1, s[12:15], s85 offen offset:256 nt
    s_waitcnt lgkmcnt(0)
    v_readfirstlane_b32 s66, v16
    s_cmp_lg_u32 s66, 0
    s_nop 3
    s_cbranch_scc1 L_cont24
    s_waitcnt vmcnt(3)
    buffer_load_dwordx4 v[244:247], v1, s[12:15], s86 offen offset:0 nt
    s_waitcnt vmcnt(3)
    buffer_load_dwordx4 v[248:251], v1, s[12:15], s86 offen offset:128 nt
    s_waitcnt vmcnt(3)
    buffer_load_dwordx4 v[252:255], v1, s[12:15], s86 offen offset:256 nt
    s_mov_b32 s63, 1048576
L_flag:
    ds_read_b32 v16, v15
    s_waitcnt lgkmcnt(0)
    v_readfirstlane_b32 s66, v16
    s_cmp_lg_u32 s66, 0
    s_nop 3
    s_cbranch_scc1 L_flagok
    s_sleep 2
    s_sub_u32 s63, s63, 1
    s_cmp_lg_u32 s63, 0
    s_cbranch_scc1 L_flag
L_flagok:
    ds_read_b128 v[20:23], v3 offset:2816
    ds_read_b128 v[24:27], v3 offset:2944
    ds_read_b128 v[28:31], v3 offset:3072
    ds_read_b32 v10, v9 offset:3200
    s_waitcnt lgkmcnt(0)
    v_mov_b32 v32, 0
    v_mov_b32 v33, 0
    v_dot2c_f32_bf16 v32, v40, v20
    v_dot2c_f32_bf16 v33, v52, v20
    v_dot2c_f32_bf16 v32, v41, v21
    v_dot2c_f32_bf16 v33, v53, v21
    v_dot2c_f32_bf16 v32, v42, v22
    v_dot2c_f32_bf16 v33, v54, v22
    v_dot2c_f32_bf16 v32, v43, v23
    v_dot2c_f32_bf16 v33, v55, v23
    v_dot2c_f32_bf16 v32, v44, v24
    v_dot2c_f32_bf16 v33, v56, v24
    v_dot2c_f32_bf16 v32, v45, v25
    v_dot2c_f32_bf16 v33, v57, v25
    v_dot2c_f32_bf16 v32, v46, v26
    v_dot2c_f32_bf16 v33, v58, v26
    v_dot2c_f32_bf16 v32, v47, v27
    v_dot2c_f32_bf16 v33, v59, v27
    v_dot2c_f32_bf16 v32, v48, v28
    v_dot2c_f32_bf16 v33, v60, v28
    v_dot2c_f32_bf16 v32, v49, v29
    v_dot2c_f32_bf16 v33, v61, v29
    v_dot2c_f32_bf16 v32, v50, v30
    v_dot2c_f32_bf16 v33, v62, v30
    v_dot2c_f32_bf16 v32, v51, v31
    v_dot2c_f32_bf16 v33, v63, v31
    s_nop 1
    v_add_f32_dpp v32, v32, v32 quad_perm:[1,0,3,2] row_mask:0xf bank_mask:0xf
    v_add_f32_dpp v33, v33, v33 quad_perm:[1,0,3,2] row_mask:0xf bank_mask:0xf
    s_nop 0
    v_add_f32_dpp v32, v32, v32 quad_perm:[2,3,0,1] row_mask:0xf bank_mask:0xf
    v_add_f32_dpp v33, v33, v33 quad_perm:[2,3,0,1] row_mask:0xf bank_mask:0xf
    s_nop 0
    v_add_f32_dpp v32, v32, v32 row_half_mirror row_mask:0xf bank_mask:0xf
    v_add_f32_dpp v33, v33, v33 row_half_mirror row_mask:0xf bank_mask:0xf
    v_cvt_pk_bf16_f32 v15, v32, v33
    v_lshlrev_b32 v32, 16, v15
    v_and_b32 v33, 0xffff0000, v15
    v_mul_f32 v32, 0x3d93cd3a, v32
    v_mul_f32 v33, 0x3d93cd3a, v33
    v_cvt_pk_bf16_f32 v15, v32, v33
    v_lshlrev_b32 v32, 16, v15
    v_and_b32 v33, 0xffff0000, v15
    v_mov_b32 v34, 0
    v_mov_b32 v35, 0
    v_dot2c_f32_bf16 v34, v64, v20
    v_dot2c_f32_bf16 v35, v76, v20
    v_dot2c_f32_bf16 v34, v65, v21
    v_dot2c_f32_bf16 v35, v77, v21
    v_dot2c_f32_bf16 v34, v66, v22
    v_dot2c_f32_bf16 v35, v78, v22
    v_dot2c_f32_bf16 v34, v67, v23
    v_dot2c_f32_bf16 v35, v79, v23
    v_dot2c_f32_bf16 v34, v68, v24
    v_dot2c_f32_bf16 v35, v80, v24
    v_dot2c_f32_bf16 v34, v69, v25
    v_dot2c_f32_bf16 v35, v81, v25
    v_dot2c_f32_bf16 v34, v70, v26
    v_dot2c_f32_bf16 v35, v82, v26
    v_dot2c_f32_bf16 v34, v71, v27
    v_dot2c_f32_bf16 v35, v83, v27
    v_dot2c_f32_bf16 v34, v72, v28
    v_dot2c_f32_bf16 v35, v84, v28
    v_dot2c_f32_bf16 v34, v73, v29
    v_dot2c_f32_bf16 v35, v85, v29
    v_dot2c_f32_bf16 v34, v74, v30
    v_dot2c_f32_bf16 v35, v86, v30
    v_dot2c_f32_bf16 v34, v75, v31
    v_dot2c_f32_bf16 v35, v87, v31
    s_nop 1
    v_add_f32_dpp v34, v34, v34 quad_perm:[1,0,3,2] row_mask:0xf bank_mask:0xf
    v_add_f32_dpp v35, v35, v35 quad_perm:[1,0,3,2] row_mask:0xf bank_mask:0xf
    s_nop 0
    v_add_f32_dpp v34, v34, v34 quad_perm:[2,3,0,1] row_mask:0xf bank_mask:0xf
    v_add_f32_dpp v35, v35, v35 quad_perm:[2,3,0,1] row_mask:0xf bank_mask:0xf
    s_nop 0
    v_add_f32_dpp v34, v34, v34 row_half_mirror row_mask:0xf bank_mask:0xf
    v_add_f32_dpp v35, v35, v35 row_half_mirror row_mask:0xf bank_mask:0xf
    v_cvt_pk_bf16_f32 v15, v34, v35
    v_lshlrev_b32 v34, 16, v15
    v_and_b32 v35, 0xffff0000, v15
    v_mul_f32 v34, 0x3d93cd3a, v34
    v_mul_f32 v35, 0x3d93cd3a, v35
    v_cvt_pk_bf16_f32 v15, v34, v35
    v_lshlrev_b32 v34, 16, v15
    v_and_b32 v35, 0xffff0000, v15
    v_mov_b32 v36, 0
    v_mov_b32 v37, 0
    v_dot2c_f32_bf16 v36, v88, v20
    v_dot2c_f32_bf16 v37, v100, v20
    v_dot2c_f32_bf16 v36, v89, v21
    v_dot2c_f32_bf16 v37, v101, v21
    v_dot2c_f32_bf16 v36, v90, v22
    v_dot2c_f32_bf16 v37, v102, v22
    v_dot2c_f32_bf16 v36, v91, v23
    v_dot2c_f32_bf16 v37, v103, v23
    v_dot2c_f32_bf16 v36, v92, v24
    v_dot2c_f32_bf16 v37, v104, v24
    v_dot2c_f32_bf16 v36, v93, v25
    v_dot2c_f32_bf16 v37, v105, v25
    v_dot2c_f32_bf16 v36, v94, v26
    v_dot2c_f32_bf16 v37, v106, v26
    v_dot2c_f32_bf16 v36, v95, v27
    v_dot2c_f32_bf16 v37, v107, v27
    v_dot2c_f32_bf16 v36, v96, v28
    v_dot2c_f32_bf16 v37, v108, v28
    v_dot2c_f32_bf16 v36, v97, v29
    v_dot2c_f32_bf16 v37, v109, v29
    v_dot2c_f32_bf16 v36, v98, v30
    v_dot2c_f32_bf16 v37, v110, v30
    v_dot2c_f32_bf16 v36, v99, v31
    v_dot2c_f32_bf16 v37, v111, v31
    s_nop 1
    v_add_f32_dpp v36, v36, v36 quad_perm:[1,0,3,2] row_mask:0xf bank_mask:0xf
    v_add_f32_dpp v37, v37, v37 quad_perm:[1,0,3,2] row_mask:0xf bank_mask:0xf
    s_nop 0
    v_add_f32_dpp v36, v36, v36 quad_perm:[2,3,0,1] row_mask:0xf bank_mask:0xf
    v_add_f32_dpp v37, v37, v37 quad_perm:[2,3,0,1] row_mask:0xf bank_mask:0xf
    s_nop 0
    v_add_f32_dpp v36, v36, v36 row_half_mirror row_mask:0xf bank_mask:0xf
    v_add_f32_dpp v37, v37, v37 row_half_mirror row_mask:0xf bank_mask:0xf
    v_cvt_pk_bf16_f32 v15, v36, v37
    v_lshlrev_b32 v36, 16, v15
    v_and_b32 v37, 0xffff0000, v15
    v_mul_f32 v36, 0x3d93cd3a, v36
    v_mul_f32 v37, 0x3d93cd3a, v37
    v_cvt_pk_bf16_f32 v15, v36, v37
    v_lshlrev_b32 v36, 16, v15
    v_and_b32 v37, 0xffff0000, v15
    v_mov_b32 v38, 0
    v_mov_b32 v39, 0
    v_dot2c_f32_bf16 v38, v112, v20
    v_dot2c_f32_bf16 v39, v124, v20
    v_dot2c_f32_bf16 v38, v113, v21
    v_dot2c_f32_bf16 v39, v125, v21
    v_dot2c_f32_bf16 v38, v114, v22
    v_dot2c_f32_bf16 v39, v126, v22
    v_dot2c_f32_bf16 v38, v115, v23
    v_dot2c_f32_bf16 v39, v127, v23
    v_dot2c_f32_bf16 v38, v116, v24
    v_dot2c_f32_bf16 v39, v128, v24
    v_dot2c_f32_bf16 v38, v117, v25
    v_dot2c_f32_bf16 v39, v129, v25
    v_dot2c_f32_bf16 v38, v118, v26
    v_dot2c_f32_bf16 v39, v130, v26
    v_dot2c_f32_bf16 v38, v119, v27
    v_dot2c_f32_bf16 v39, v131, v27
    v_dot2c_f32_bf16 v38, v120, v28
    v_dot2c_f32_bf16 v39, v132, v28
    v_dot2c_f32_bf16 v38, v121, v29
    v_dot2c_f32_bf16 v39, v133, v29
    v_dot2c_f32_bf16 v38, v122, v30
    v_dot2c_f32_bf16 v39, v134, v30
    v_dot2c_f32_bf16 v38, v123, v31
    v_dot2c_f32_bf16 v39, v135, v31
    s_nop 1
    v_add_f32_dpp v38, v38, v38 quad_perm:[1,0,3,2] row_mask:0xf bank_mask:0xf
    v_add_f32_dpp v39, v39, v39 quad_perm:[1,0,3,2] row_mask:0xf bank_mask:0xf
    s_nop 0
    v_add_f32_dpp v38, v38, v38 quad_perm:[2,3,0,1] row_mask:0xf bank_mask:0xf
    v_add_f32_dpp v39, v39, v39 quad_perm:[2,3,0,1] row_mask:0xf bank_mask:0xf
    s_nop 0
    v_add_f32_dpp v38, v38, v38 row_half_mirror row_mask:0xf bank_mask:0xf
    v_add_f32_dpp v39, v39, v39 row_half_mirror row_mask:0xf bank_mask:0xf
    v_cvt_pk_bf16_f32 v15, v38, v39
    v_lshlrev_b32 v38, 16, v15
    v_and_b32 v39, 0xffff0000, v15
    v_mul_f32 v38, 0x3d93cd3a, v38
    v_mul_f32 v39, 0x3d93cd3a, v39
    v_cvt_pk_bf16_f32 v15, v38, v39
    v_lshlrev_b32 v38, 16, v15
    v_and_b32 v39, 0xffff0000, v15
    v_mov_b32 v19, 0
    v_dot2c_f32_bf16 v19, v136, v20
    v_dot2c_f32_bf16 v19, v137, v21
    v_dot2c_f32_bf16 v19, v138, v22
    v_dot2c_f32_bf16 v19, v139, v23
    v_dot2c_f32_bf16 v19, v140, v24
    v_dot2c_f32_bf16 v19, v141, v25
    v_dot2c_f32_bf16 v19, v142, v26
    v_dot2c_f32_bf16 v19, v143, v27
    v_dot2c_f32_bf16 v19, v144, v28
    v_dot2c_f32_bf16 v19, v145, v29
    v_dot2c_f32_bf16 v19, v146, v30
    v_dot2c_f32_bf16 v19, v147, v31
    s_nop 2
    v_add_f32_dpp v19, v19, v19 quad_perm:[1,0,3,2] row_mask:0xf bank_mask:0xf
    s_nop 1
    v_add_f32_dpp v19, v19, v19 quad_perm:[2,3,0,1] row_mask:0xf bank_mask:0xf
    s_nop 1
    v_add_f32_dpp v19, v19, v19 row_half_mirror row_mask:0xf bank_mask:0xf
    v_cvt_pk_bf16_f32 v15, v19, v19
    v_lshlrev_b32 v19, 16, v15
    v_mul_f32 v19, 0x3d93cd3a, v19
    v_cvt_pk_bf16_f32 v15, v19, v19
    v_lshlrev_b32 v19, 16, v15
    v_mov_b32 v15, v32
    v_max3_f32 v15, v15, v33, v34
    v_max3_f32 v15, v15, v35, v36
    v_max3_f32 v15, v15, v37, v38
    v_max3_f32 v15, v15, v39, v19
    s_nop 1
    v_max_f32_dpp v15, v15, v15 row_ror:8 row_mask:0xf bank_mask:0xf
    v_mov_b32 v40, 0
    v_mov_b32 v41, 0
    v_mov_b32 v42, 0
    v_mov_b32 v43, 0
    v_mov_b32 v44, 0
    v_mov_b32 v45, 0
    v_mov_b32 v46, 0
    v_mov_b32 v47, 0
    v_mov_b32 v48, 0
    v_mov_b32 v49, 0
    v_mov_b32 v50, 0
    v_mov_b32 v51, 0
    v_mov_b32 v16, v15
    s_nop 1
    v_permlane16_swap_b32 v15, v16
    v_max_f32 v15, v15, v16
    v_mov_b32 v16, v15
    s_nop 1
    v_permlane32_swap_b32 v15, v16
    v_max_f32 v15, v15, v16
    v_mul_f32 v12, 0x3fb8aa3b, v15
    v_and_b32 v17, 1, v2
    v_lshlrev_b32 v17, 4, v17
    v_mov_b32 v18, 0xffff
    v_lshlrev_b32 v18, v17, v18
    v_bfe_u32 v17, v2, 1, 2
    v_cmp_eq_u32 vcc, 0, v17
    s_nop 1
    v_cndmask_b32 v52, 0, v18, vcc
    v_cmp_eq_u32 vcc, 1, v17
    s_nop 1
    v_cndmask_b32 v53, 0, v18, vcc
    v_cmp_eq_u32 vcc, 2, v17
    s_nop 1
    v_cndmask_b32 v54, 0, v18, vcc
    v_cmp_eq_u32 vcc, 3, v17
    s_nop 1
    v_cndmask_b32 v55, 0, v18, vcc
    s_mov_b32 s62, 0x3fb8aa3b
    v_fma_f32 v32, v32, s62, -v12
    v_fma_f32 v33, v33, s62, -v12
    v_fma_f32 v34, v34, s62, -v12
    v_fma_f32 v35, v35, s62, -v12
    v_fma_f32 v36, v36, s62, -v12
    v_fma_f32 v37, v37, s62, -v12
    v_fma_f32 v38, v38, s62, -v12
    v_fma_f32 v39, v39, s62, -v12
    v_fma_f32 v19, v19, s62, -v12
    v_exp_f32 v32, v32
    v_exp_f32 v33, v33
    v_exp_f32 v34, v34
    v_exp_f32 v35, v35
    v_exp_f32 v36, v36
    v_exp_f32 v37, v37
    v_exp_f32 v38, v38
    v_exp_f32 v39, v39
    v_exp_f32 v19, v19
    v_cvt_pk_bf16_f32 v32, v32, v32
    v_cvt_pk_bf16_f32 v33, v33, v33
    v_cvt_pk_bf16_f32 v34, v34, v34
    v_cvt_pk_bf16_f32 v35, v35, v35
    v_cvt_pk_bf16_f32 v36, v36, v36
    v_cvt_pk_bf16_f32 v37, v37, v37
    v_cvt_pk_bf16_f32 v38, v38, v38
    v_cvt_pk_bf16_f32 v39, v39, v39
    v_cvt_pk_bf16_f32 v19, v19, v19
    v_and_b32 v56, v52, v32
    v_and_b32 v57, v53, v32
    v_and_b32 v58, v54, v32
    v_and_b32 v59, v55, v32
    v_and_b32 v60, v52, v33
    v_and_b32 v61, v53, v33
    v_and_b32 v62, v54, v33
    v_and_b32 v63, v55, v33
    v_and_b32 v64, v52, v34
    v_and_b32 v65, v53, v34
    v_and_b32 v66, v54, v34
    v_and_b32 v67, v55, v34
    v_and_b32 v68, v52, v35
    v_and_b32 v69, v53, v35
    v_and_b32 v70, v54, v35
    v_and_b32 v71, v55, v35
    v_and_b32 v72, v52, v36
    v_and_b32 v73, v53, v36
    v_and_b32 v74, v54, v36
    v_and_b32 v75, v55, v36
    v_and_b32 v76, v52, v37
    v_and_b32 v77, v53, v37
    v_and_b32 v78, v54, v37
    v_and_b32 v79, v55, v37
    v_and_b32 v80, v52, v38
    v_and_b32 v81, v53, v38
    v_and_b32 v82, v54, v38
    v_and_b32 v83, v55, v38
    v_and_b32 v84, v52, v39
    v_and_b32 v85, v53, v39
    v_and_b32 v86, v54, v39
    v_and_b32 v87, v55, v39
    v_and_b32 v88, v52, v19
    v_and_b32 v89, v53, v19
    v_and_b32 v90, v54, v19
    v_and_b32 v91, v55, v19
    s_waitcnt vmcnt(3)
    buffer_load_dwordx4 v[116:119], v5, s[36:39], s53 offen offset:0 nt
    v_and_b32 v13, 0xffff0000, v32
    v_and_b32 v15, 0xffff0000, v33
    v_add_f32 v13, v13, v15
    v_and_b32 v15, 0xffff0000, v34
    v_add_f32 v13, v13, v15
    v_and_b32 v15, 0xffff0000, v35
    v_add_f32 v13, v13, v15
    v_and_b32 v15, 0xffff0000, v36
    v_add_f32 v13, v13, v15
    v_and_b32 v15, 0xffff0000, v37
    v_add_f32 v13, v13, v15
    v_and_b32 v15, 0xffff0000, v38
    v_add_f32 v13, v13, v15
    v_and_b32 v15, 0xffff0000, v39
    v_add_f32 v13, v13, v15
    v_and_b32 v15, 0xffff0000, v19
    v_add_f32 v13, v13, v15
    s_nop 1
    v_add_f32_dpp v13, v13, v13 row_ror:8 row_mask:0xf bank_mask:0xf
    v_mov_b32 v16, v13
    s_nop 1
    v_permlane16_swap_b32 v13, v16
    v_add_f32 v13, v13, v16
    v_mov_b32 v16, v13
    s_nop 1
    v_permlane32_swap_b32 v13, v16
    v_add_f32 v13, v13, v16
    s_lshl_b32 s62, s3, 3
    v_mov_b32 v16, s62
    ds_write_b64 v16, v[12:13] offset:3584
    v_mfma_f32_16x16x32_bf16 v[40:43], v[56:59], v[148:151], v[40:43]
    v_mfma_f32_16x16x32_bf16 v[44:47], v[56:59], v[152:155], v[44:47]
    v_mfma_f32_16x16x32_bf16 v[48:51], v[56:59], v[156:159], v[48:51]
    v_mfma_f32_16x16x32_bf16 v[40:43], v[60:63], v[160:163], v[40:43]
    v_mfma_f32_16x16x32_bf16 v[44:47], v[60:63], v[164:167], v[44:47]
    v_mfma_f32_16x16x32_bf16 v[48:51], v[60:63], v[168:171], v[48:51]
    v_mfma_f32_16x16x32_bf16 v[40:43], v[64:67], v[172:175], v[40:43]
    v_mfma_f32_16x16x32_bf16 v[44:47], v[64:67], v[176:179], v[44:47]
    s_waitcnt vmcnt(3)
    buffer_load_dwordx4 v[120:123], v5, s[36:39], s53 offen offset:1280 nt
    v_mfma_f32_16x16x32_bf16 v[48:51], v[64:67], v[180:183], v[48:51]
    v_mfma_f32_16x16x32_bf16 v[40:43], v[68:71], v[184:187], v[40:43]
    v_mfma_f32_16x16x32_bf16 v[44:47], v[68:71], v[188:191], v[44:47]
    v_mfma_f32_16x16x32_bf16 v[48:51], v[68:71], v[192:195], v[48:51]
    v_mfma_f32_16x16x32_bf16 v[40:43], v[72:75], v[196:199], v[40:43]
    v_mfma_f32_16x16x32_bf16 v[44:47], v[72:75], v[200:203], v[44:47]
    v_mfma_f32_16x16x32_bf16 v[48:51], v[72:75], v[204:207], v[48:51]
    v_mfma_f32_16x16x32_bf16 v[40:43], v[76:79], v[208:211], v[40:43]
    v_mfma_f32_16x16x32_bf16 v[44:47], v[76:79], v[212:215], v[44:47]
    v_mfma_f32_16x16x32_bf16 v[48:51], v[76:79], v[216:219], v[48:51]
    v_mfma_f32_16x16x32_bf16 v[40:43], v[80:83], v[220:223], v[40:43]
    v_mfma_f32_16x16x32_bf16 v[44:47], v[80:83], v[224:227], v[44:47]
    v_mfma_f32_16x16x32_bf16 v[48:51], v[80:83], v[228:231], v[48:51]
    v_mfma_f32_16x16x32_bf16 v[40:43], v[84:87], v[232:235], v[40:43]
    v_mfma_f32_16x16x32_bf16 v[44:47], v[84:87], v[236:239], v[44:47]
    v_mfma_f32_16x16x32_bf16 v[48:51], v[84:87], v[240:243], v[48:51]
    s_waitcnt vmcnt(3)
    buffer_load_dwordx4 v[92:95], v4, s[24:27], s52 offen offset:0 nt
    v_mfma_f32_16x16x32_bf16 v[40:43], v[88:91], v[244:247], v[40:43]
    v_mfma_f32_16x16x32_bf16 v[44:47], v[88:91], v[248:251], v[44:47]
    buffer_load_dwordx4 v[96:99], v4, s[24:27], s52 offen offset:1280 nt
    buffer_load_dwordx4 v[100:103], v4, s[24:27], s52 offen offset:2560 nt
    buffer_load_dwordx4 v[104:107], v4, s[24:27], s52 offen offset:3840 nt
    buffer_load_dwordx4 v[108:111], v4, s[24:27], s64 offen offset:0 nt
    buffer_load_dwordx4 v[112:115], v4, s[24:27], s64 offen offset:1280 nt
    s_waitcnt vmcnt(8)
    v_mfma_f32_16x16x32_bf16 v[48:51], v[88:91], v[252:255], v[48:51]
    s_nop 7
    s_branch L_tail
L_cont4:
    ds_read_b128 v[20:23], v3 offset:2816
    ds_read_b128 v[24:27], v3 offset:2944
    ds_read_b128 v[28:31], v3 offset:3072
    ds_read_b32 v10, v9 offset:3200
    s_waitcnt vmcnt(3)
    buffer_load_dwordx4 v[164:167], v1, s[12:15], s79 offen offset:128 nt
    s_waitcnt lgkmcnt(0)
    v_mov_b32 v32, 0
    v_mov_b32 v33, 0
    v_dot2c_f32_bf16 v32, v40, v20
    v_dot2c_f32_bf16 v33, v52, v20
    v_dot2c_f32_bf16 v32, v41, v21
    v_dot2c_f32_bf16 v33, v53, v21
    v_dot2c_f32_bf16 v32, v42, v22
    v_dot2c_f32_bf16 v33, v54, v22
    v_dot2c_f32_bf16 v32, v43, v23
    v_dot2c_f32_bf16 v33, v55, v23
    v_dot2c_f32_bf16 v32, v44, v24
    v_dot2c_f32_bf16 v33, v56, v24
    v_dot2c_f32_bf16 v32, v45, v25
    v_dot2c_f32_bf16 v33, v57, v25
    v_dot2c_f32_bf16 v32, v46, v26
    v_dot2c_f32_bf16 v33, v58, v26
    v_dot2c_f32_bf16 v32, v47, v27
    v_dot2c_f32_bf16 v33, v59, v27
    v_dot2c_f32_bf16 v32, v48, v28
    v_dot2c_f32_bf16 v33, v60, v28
    v_dot2c_f32_bf16 v32, v49, v29
    v_dot2c_f32_bf16 v33, v61, v29
    v_dot2c_f32_bf16 v32, v50, v30
    v_dot2c_f32_bf16 v33, v62, v30
    v_dot2c_f32_bf16 v32, v51, v31
    v_dot2c_f32_bf16 v33, v63, v31
    s_nop 1
    v_add_f32_dpp v32, v32, v32 quad_perm:[1,0,3,2] row_mask:0xf bank_mask:0xf
    v_add_f32_dpp v33, v33, v33 quad_perm:[1,0,3,2] row_mask:0xf bank_mask:0xf
    s_nop 0
    v_add_f32_dpp v32, v32, v32 quad_perm:[2,3,0,1] row_mask:0xf bank_mask:0xf
    v_add_f32_dpp v33, v33, v33 quad_perm:[2,3,0,1] row_mask:0xf bank_mask:0xf
    s_nop 0
    v_add_f32_dpp v32, v32, v32 row_half_mirror row_mask:0xf bank_mask:0xf
    v_add_f32_dpp v33, v33, v33 row_half_mirror row_mask:0xf bank_mask:0xf
    v_cvt_pk_bf16_f32 v15, v32, v33
    v_lshlrev_b32 v32, 16, v15
    v_and_b32 v33, 0xffff0000, v15
    v_mul_f32 v32, 0x3d93cd3a, v32
    v_mul_f32 v33, 0x3d93cd3a, v33
    v_cvt_pk_bf16_f32 v15, v32, v33
    v_lshlrev_b32 v32, 16, v15
    v_and_b32 v33, 0xffff0000, v15
    s_waitcnt vmcnt(3)
    buffer_load_dwordx4 v[168:171], v1, s[12:15], s79 offen offset:256 nt
    v_mov_b32 v34, 0
    v_mov_b32 v35, 0
    v_dot2c_f32_bf16 v34, v64, v20
    v_dot2c_f32_bf16 v35, v76, v20
    v_dot2c_f32_bf16 v34, v65, v21
    v_dot2c_f32_bf16 v35, v77, v21
    v_dot2c_f32_bf16 v34, v66, v22
    v_dot2c_f32_bf16 v35, v78, v22
    v_dot2c_f32_bf16 v34, v67, v23
    v_dot2c_f32_bf16 v35, v79, v23
    v_dot2c_f32_bf16 v34, v68, v24
    v_dot2c_f32_bf16 v35, v80, v24
    v_dot2c_f32_bf16 v34, v69, v25
    v_dot2c_f32_bf16 v35, v81, v25
    v_dot2c_f32_bf16 v34, v70, v26
    v_dot2c_f32_bf16 v35, v82, v26
    v_dot2c_f32_bf16 v34, v71, v27
    v_dot2c_f32_bf16 v35, v83, v27
    v_dot2c_f32_bf16 v34, v72, v28
    v_dot2c_f32_bf16 v35, v84, v28
    v_dot2c_f32_bf16 v34, v73, v29
    v_dot2c_f32_bf16 v35, v85, v29
    v_dot2c_f32_bf16 v34, v74, v30
    v_dot2c_f32_bf16 v35, v86, v30
    v_dot2c_f32_bf16 v34, v75, v31
    v_dot2c_f32_bf16 v35, v87, v31
    s_nop 1
    v_add_f32_dpp v34, v34, v34 quad_perm:[1,0,3,2] row_mask:0xf bank_mask:0xf
    v_add_f32_dpp v35, v35, v35 quad_perm:[1,0,3,2] row_mask:0xf bank_mask:0xf
    s_nop 0
    v_add_f32_dpp v34, v34, v34 quad_perm:[2,3,0,1] row_mask:0xf bank_mask:0xf
    v_add_f32_dpp v35, v35, v35 quad_perm:[2,3,0,1] row_mask:0xf bank_mask:0xf
    s_nop 0
    v_add_f32_dpp v34, v34, v34 row_half_mirror row_mask:0xf bank_mask:0xf
    v_add_f32_dpp v35, v35, v35 row_half_mirror row_mask:0xf bank_mask:0xf
    v_cvt_pk_bf16_f32 v15, v34, v35
    v_lshlrev_b32 v34, 16, v15
    v_and_b32 v35, 0xffff0000, v15
    v_mul_f32 v34, 0x3d93cd3a, v34
    v_mul_f32 v35, 0x3d93cd3a, v35
    v_cvt_pk_bf16_f32 v15, v34, v35
    v_lshlrev_b32 v34, 16, v15
    v_and_b32 v35, 0xffff0000, v15
    s_waitcnt vmcnt(3)
    buffer_load_dwordx4 v[172:175], v1, s[12:15], s80 offen offset:0 nt
    v_mov_b32 v36, 0
    v_mov_b32 v37, 0
    v_dot2c_f32_bf16 v36, v88, v20
    v_dot2c_f32_bf16 v37, v100, v20
    v_dot2c_f32_bf16 v36, v89, v21
    v_dot2c_f32_bf16 v37, v101, v21
    v_dot2c_f32_bf16 v36, v90, v22
    v_dot2c_f32_bf16 v37, v102, v22
    v_dot2c_f32_bf16 v36, v91, v23
    v_dot2c_f32_bf16 v37, v103, v23
    v_dot2c_f32_bf16 v36, v92, v24
    v_dot2c_f32_bf16 v37, v104, v24
    v_dot2c_f32_bf16 v36, v93, v25
    v_dot2c_f32_bf16 v37, v105, v25
    v_dot2c_f32_bf16 v36, v94, v26
    v_dot2c_f32_bf16 v37, v106, v26
    v_dot2c_f32_bf16 v36, v95, v27
    v_dot2c_f32_bf16 v37, v107, v27
    v_dot2c_f32_bf16 v36, v96, v28
    v_dot2c_f32_bf16 v37, v108, v28
    v_dot2c_f32_bf16 v36, v97, v29
    v_dot2c_f32_bf16 v37, v109, v29
    v_dot2c_f32_bf16 v36, v98, v30
    v_dot2c_f32_bf16 v37, v110, v30
    v_dot2c_f32_bf16 v36, v99, v31
    v_dot2c_f32_bf16 v37, v111, v31
    s_nop 1
    v_add_f32_dpp v36, v36, v36 quad_perm:[1,0,3,2] row_mask:0xf bank_mask:0xf
    v_add_f32_dpp v37, v37, v37 quad_perm:[1,0,3,2] row_mask:0xf bank_mask:0xf
    s_nop 0
    v_add_f32_dpp v36, v36, v36 quad_perm:[2,3,0,1] row_mask:0xf bank_mask:0xf
    v_add_f32_dpp v37, v37, v37 quad_perm:[2,3,0,1] row_mask:0xf bank_mask:0xf
    s_nop 0
    v_add_f32_dpp v36, v36, v36 row_half_mirror row_mask:0xf bank_mask:0xf
    v_add_f32_dpp v37, v37, v37 row_half_mirror row_mask:0xf bank_mask:0xf
    v_cvt_pk_bf16_f32 v15, v36, v37
    v_lshlrev_b32 v36, 16, v15
    v_and_b32 v37, 0xffff0000, v15
    v_mul_f32 v36, 0x3d93cd3a, v36
    v_mul_f32 v37, 0x3d93cd3a, v37
    v_cvt_pk_bf16_f32 v15, v36, v37
    v_lshlrev_b32 v36, 16, v15
    v_and_b32 v37, 0xffff0000, v15
    s_waitcnt vmcnt(3)
    buffer_load_dwordx4 v[176:179], v1, s[12:15], s80 offen offset:128 nt
    v_mov_b32 v38, 0
    v_mov_b32 v39, 0
    v_dot2c_f32_bf16 v38, v112, v20
    v_dot2c_f32_bf16 v39, v124, v20
    v_dot2c_f32_bf16 v38, v113, v21
    v_dot2c_f32_bf16 v39, v125, v21
    v_dot2c_f32_bf16 v38, v114, v22
    v_dot2c_f32_bf16 v39, v126, v22
    v_dot2c_f32_bf16 v38, v115, v23
    v_dot2c_f32_bf16 v39, v127, v23
    v_dot2c_f32_bf16 v38, v116, v24
    v_dot2c_f32_bf16 v39, v128, v24
    v_dot2c_f32_bf16 v38, v117, v25
    v_dot2c_f32_bf16 v39, v129, v25
    v_dot2c_f32_bf16 v38, v118, v26
    v_dot2c_f32_bf16 v39, v130, v26
    v_dot2c_f32_bf16 v38, v119, v27
    v_dot2c_f32_bf16 v39, v131, v27
    v_dot2c_f32_bf16 v38, v120, v28
    v_dot2c_f32_bf16 v39, v132, v28
    v_dot2c_f32_bf16 v38, v121, v29
    v_dot2c_f32_bf16 v39, v133, v29
    v_dot2c_f32_bf16 v38, v122, v30
    v_dot2c_f32_bf16 v39, v134, v30
    v_dot2c_f32_bf16 v38, v123, v31
    v_dot2c_f32_bf16 v39, v135, v31
    s_nop 1
    v_add_f32_dpp v38, v38, v38 quad_perm:[1,0,3,2] row_mask:0xf bank_mask:0xf
    v_add_f32_dpp v39, v39, v39 quad_perm:[1,0,3,2] row_mask:0xf bank_mask:0xf
    s_nop 0
    v_add_f32_dpp v38, v38, v38 quad_perm:[2,3,0,1] row_mask:0xf bank_mask:0xf
    v_add_f32_dpp v39, v39, v39 quad_perm:[2,3,0,1] row_mask:0xf bank_mask:0xf
    s_nop 0
    v_add_f32_dpp v38, v38, v38 row_half_mirror row_mask:0xf bank_mask:0xf
    v_add_f32_dpp v39, v39, v39 row_half_mirror row_mask:0xf bank_mask:0xf
    v_cvt_pk_bf16_f32 v15, v38, v39
    v_lshlrev_b32 v38, 16, v15
    v_and_b32 v39, 0xffff0000, v15
    v_mul_f32 v38, 0x3d93cd3a, v38
    v_mul_f32 v39, 0x3d93cd3a, v39
    v_cvt_pk_bf16_f32 v15, v38, v39
    v_lshlrev_b32 v38, 16, v15
    v_and_b32 v39, 0xffff0000, v15
    s_waitcnt vmcnt(3)
    buffer_load_dwordx4 v[180:183], v1, s[12:15], s80 offen offset:256 nt
    v_mov_b32 v19, 0
    v_dot2c_f32_bf16 v19, v136, v20
    v_dot2c_f32_bf16 v19, v137, v21
    v_dot2c_f32_bf16 v19, v138, v22
    v_dot2c_f32_bf16 v19, v139, v23
    v_dot2c_f32_bf16 v19, v140, v24
    v_dot2c_f32_bf16 v19, v141, v25
    v_dot2c_f32_bf16 v19, v142, v26
    v_dot2c_f32_bf16 v19, v143, v27
    v_dot2c_f32_bf16 v19, v144, v28
    v_dot2c_f32_bf16 v19, v145, v29
    v_dot2c_f32_bf16 v19, v146, v30
    v_dot2c_f32_bf16 v19, v147, v31
    s_nop 2
    v_add_f32_dpp v19, v19, v19 quad_perm:[1,0,3,2] row_mask:0xf bank_mask:0xf
    s_nop 1
    v_add_f32_dpp v19, v19, v19 quad_perm:[2,3,0,1] row_mask:0xf bank_mask:0xf
    s_nop 1
    v_add_f32_dpp v19, v19, v19 row_half_mirror row_mask:0xf bank_mask:0xf
    v_cvt_pk_bf16_f32 v15, v19, v19
    v_lshlrev_b32 v19, 16, v15
    v_mul_f32 v19, 0x3d93cd3a, v19
    v_cvt_pk_bf16_f32 v15, v19, v19
    v_lshlrev_b32 v19, 16, v15
    s_waitcnt vmcnt(3)
    buffer_load_dwordx4 v[184:187], v1, s[12:15], s81 offen offset:0 nt
    v_mov_b32 v15, v32
    v_max3_f32 v15, v15, v33, v34
    v_max3_f32 v15, v15, v35, v36
    v_max3_f32 v15, v15, v37, v38
    v_max3_f32 v15, v15, v39, v19
    s_nop 1
    v_max_f32_dpp v15, v15, v15 row_ror:8 row_mask:0xf bank_mask:0xf
    v_mov_b32 v40, 0
    v_mov_b32 v41, 0
    v_mov_b32 v42, 0
    v_mov_b32 v43, 0
    v_mov_b32 v44, 0
    v_mov_b32 v45, 0
    v_mov_b32 v46, 0
    v_mov_b32 v47, 0
    v_mov_b32 v48, 0
    v_mov_b32 v49, 0
    v_mov_b32 v50, 0
    v_mov_b32 v51, 0
    v_mov_b32 v16, v15
    s_nop 1
    v_permlane16_swap_b32 v15, v16
    v_max_f32 v15, v15, v16
    v_mov_b32 v16, v15
    s_nop 1
    v_permlane32_swap_b32 v15, v16
    v_max_f32 v15, v15, v16
    v_mul_f32 v12, 0x3fb8aa3b, v15
    v_and_b32 v17, 1, v2
    v_lshlrev_b32 v17, 4, v17
    v_mov_b32 v18, 0xffff
    v_lshlrev_b32 v18, v17, v18
    v_bfe_u32 v17, v2, 1, 2
    v_cmp_eq_u32 vcc, 0, v17
    s_nop 1
    v_cndmask_b32 v52, 0, v18, vcc
    v_cmp_eq_u32 vcc, 1, v17
    s_nop 1
    v_cndmask_b32 v53, 0, v18, vcc
    v_cmp_eq_u32 vcc, 2, v17
    s_nop 1
    v_cndmask_b32 v54, 0, v18, vcc
    v_cmp_eq_u32 vcc, 3, v17
    s_nop 1
    v_cndmask_b32 v55, 0, v18, vcc
    s_waitcnt vmcnt(3)
    buffer_load_dwordx4 v[188:191], v1, s[12:15], s81 offen offset:128 nt
    s_mov_b32 s62, 0x3fb8aa3b
    v_fma_f32 v32, v32, s62, -v12
    v_fma_f32 v33, v33, s62, -v12
    v_fma_f32 v34, v34, s62, -v12
    v_fma_f32 v35, v35, s62, -v12
    v_fma_f32 v36, v36, s62, -v12
    v_fma_f32 v37, v37, s62, -v12
    v_fma_f32 v38, v38, s62, -v12
    v_fma_f32 v39, v39, s62, -v12
    v_fma_f32 v19, v19, s62, -v12
    v_exp_f32 v32, v32
    v_exp_f32 v33, v33
    v_exp_f32 v34, v34
    v_exp_f32 v35, v35
    v_exp_f32 v36, v36
    v_exp_f32 v37, v37
    v_exp_f32 v38, v38
    v_exp_f32 v39, v39
    v_exp_f32 v19, v19
    v_cvt_pk_bf16_f32 v32, v32, v32
    v_cvt_pk_bf16_f32 v33, v33, v33
    v_cvt_pk_bf16_f32 v34, v34, v34
    v_cvt_pk_bf16_f32 v35, v35, v35
    v_cvt_pk_bf16_f32 v36, v36, v36
    v_cvt_pk_bf16_f32 v37, v37, v37
    v_cvt_pk_bf16_f32 v38, v38, v38
    v_cvt_pk_bf16_f32 v39, v39, v39
    v_cvt_pk_bf16_f32 v19, v19, v19
    s_waitcnt vmcnt(3)
    buffer_load_dwordx4 v[192:195], v1, s[12:15], s81 offen offset:256 nt
    v_and_b32 v56, v52, v32
    v_and_b32 v57, v53, v32
    v_and_b32 v58, v54, v32
    v_and_b32 v59, v55, v32
    v_and_b32 v60, v52, v33
    v_and_b32 v61, v53, v33
    v_and_b32 v62, v54, v33
    v_and_b32 v63, v55, v33
    v_and_b32 v64, v52, v34
    v_and_b32 v65, v53, v34
    v_and_b32 v66, v54, v34
    v_and_b32 v67, v55, v34
    v_and_b32 v68, v52, v35
    v_and_b32 v69, v53, v35
    v_and_b32 v70, v54, v35
    v_and_b32 v71, v55, v35
    v_and_b32 v72, v52, v36
    v_and_b32 v73, v53, v36
    v_and_b32 v74, v54, v36
    v_and_b32 v75, v55, v36
    v_and_b32 v76, v52, v37
    v_and_b32 v77, v53, v37
    v_and_b32 v78, v54, v37
    v_and_b32 v79, v55, v37
    v_and_b32 v80, v52, v38
    v_and_b32 v81, v53, v38
    v_and_b32 v82, v54, v38
    v_and_b32 v83, v55, v38
    v_and_b32 v84, v52, v39
    v_and_b32 v85, v53, v39
    v_and_b32 v86, v54, v39
    v_and_b32 v87, v55, v39
    v_and_b32 v88, v52, v19
    v_and_b32 v89, v53, v19
    v_and_b32 v90, v54, v19
    v_and_b32 v91, v55, v19
    s_waitcnt vmcnt(3)
    buffer_load_dwordx4 v[196:199], v1, s[12:15], s82 offen offset:0 nt
    v_and_b32 v13, 0xffff0000, v32
    v_and_b32 v15, 0xffff0000, v33
    v_add_f32 v13, v13, v15
    v_and_b32 v15, 0xffff0000, v34
    v_add_f32 v13, v13, v15
    v_and_b32 v15, 0xffff0000, v35
    v_add_f32 v13, v13, v15
    v_and_b32 v15, 0xffff0000, v36
    v_add_f32 v13, v13, v15
    v_and_b32 v15, 0xffff0000, v37
    v_add_f32 v13, v13, v15
    v_and_b32 v15, 0xffff0000, v38
    v_add_f32 v13, v13, v15
    v_and_b32 v15, 0xffff0000, v39
    v_add_f32 v13, v13, v15
    v_and_b32 v15, 0xffff0000, v19
    v_add_f32 v13, v13, v15
    s_nop 1
    v_add_f32_dpp v13, v13, v13 row_ror:8 row_mask:0xf bank_mask:0xf
    v_mov_b32 v16, v13
    s_nop 1
    v_permlane16_swap_b32 v13, v16
    v_add_f32 v13, v13, v16
    v_mov_b32 v16, v13
    s_nop 1
    v_permlane32_swap_b32 v13, v16
    v_add_f32 v13, v13, v16
    s_lshl_b32 s62, s3, 3
    v_mov_b32 v16, s62
    ds_write_b64 v16, v[12:13] offset:3584
    s_waitcnt vmcnt(3)
    buffer_load_dwordx4 v[200:203], v1, s[12:15], s82 offen offset:128 nt
    v_mfma_f32_16x16x32_bf16 v[40:43], v[56:59], v[148:151], v[40:43]
    v_mfma_f32_16x16x32_bf16 v[44:47], v[56:59], v[152:155], v[44:47]
    v_mfma_f32_16x16x32_bf16 v[48:51], v[56:59], v[156:159], v[48:51]
    v_mfma_f32_16x16x32_bf16 v[40:43], v[60:63], v[160:163], v[40:43]
    v_mfma_f32_16x16x32_bf16 v[44:47], v[60:63], v[164:167], v[44:47]
    v_mfma_f32_16x16x32_bf16 v[48:51], v[60:63], v[168:171], v[48:51]
    v_mfma_f32_16x16x32_bf16 v[40:43], v[64:67], v[172:175], v[40:43]
    v_mfma_f32_16x16x32_bf16 v[44:47], v[64:67], v[176:179], v[44:47]
    s_waitcnt vmcnt(3)
    buffer_load_dwordx4 v[204:207], v1, s[12:15], s82 offen offset:256 nt
    v_mfma_f32_16x16x32_bf16 v[48:51], v[64:67], v[180:183], v[48:51]
    v_mfma_f32_16x16x32_bf16 v[40:43], v[68:71], v[184:187], v[40:43]
    v_mfma_f32_16x16x32_bf16 v[44:47], v[68:71], v[188:191], v[44:47]
    s_waitcnt vmcnt(3)
    buffer_load_dwordx4 v[208:211], v1, s[12:15], s83 offen offset:0 nt
    v_mfma_f32_16x16x32_bf16 v[48:51], v[68:71], v[192:195], v[48:51]
    s_waitcnt vmcnt(3)
    buffer_load_dwordx4 v[212:215], v1, s[12:15], s83 offen offset:128 nt
    v_mfma_f32_16x16x32_bf16 v[40:43], v[72:75], v[196:199], v[40:43]
    s_waitcnt vmcnt(3)
    buffer_load_dwordx4 v[216:219], v1, s[12:15], s83 offen offset:256 nt
    v_mfma_f32_16x16x32_bf16 v[44:47], v[72:75], v[200:203], v[44:47]
    s_waitcnt vmcnt(3)
    buffer_load_dwordx4 v[220:223], v1, s[12:15], s84 offen offset:0 nt
    v_mfma_f32_16x16x32_bf16 v[48:51], v[72:75], v[204:207], v[48:51]
    s_waitcnt vmcnt(3)
    buffer_load_dwordx4 v[224:227], v1, s[12:15], s84 offen offset:128 nt
    v_mfma_f32_16x16x32_bf16 v[40:43], v[76:79], v[208:211], v[40:43]
    s_waitcnt vmcnt(3)
    buffer_load_dwordx4 v[228:231], v1, s[12:15], s84 offen offset:256 nt
    v_mfma_f32_16x16x32_bf16 v[44:47], v[76:79], v[212:215], v[44:47]
    s_waitcnt vmcnt(3)
    buffer_load_dwordx4 v[232:235], v1, s[12:15], s85 offen offset:0 nt
    v_mfma_f32_16x16x32_bf16 v[48:51], v[76:79], v[216:219], v[48:51]
    s_waitcnt vmcnt(3)
    buffer_load_dwordx4 v[236:239], v1, s[12:15], s85 offen offset:128 nt
    v_mfma_f32_16x16x32_bf16 v[40:43], v[80:83], v[220:223], v[40:43]
    s_waitcnt vmcnt(3)
    buffer_load_dwordx4 v[240:243], v1, s[12:15], s85 offen offset:256 nt
    v_mfma_f32_16x16x32_bf16 v[44:47], v[80:83], v[224:227], v[44:47]
    s_waitcnt vmcnt(3)
    buffer_load_dwordx4 v[244:247], v1, s[12:15], s86 offen offset:0 nt
    v_mfma_f32_16x16x32_bf16 v[48:51], v[80:83], v[228:231], v[48:51]
    s_waitcnt vmcnt(3)
    buffer_load_dwordx4 v[248:251], v1, s[12:15], s86 offen offset:128 nt
    v_mfma_f32_16x16x32_bf16 v[40:43], v[84:87], v[232:235], v[40:43]
    s_waitcnt vmcnt(3)
    buffer_load_dwordx4 v[252:255], v1, s[12:15], s86 offen offset:256 nt
    v_mfma_f32_16x16x32_bf16 v[44:47], v[84:87], v[236:239], v[44:47]
    s_waitcnt vmcnt(3)
    buffer_load_dwordx4 v[116:119], v5, s[36:39], s53 offen offset:0 nt
    v_mfma_f32_16x16x32_bf16 v[48:51], v[84:87], v[240:243], v[48:51]
    s_waitcnt vmcnt(3)
    buffer_load_dwordx4 v[120:123], v5, s[36:39], s53 offen offset:1280 nt
    v_mfma_f32_16x16x32_bf16 v[40:43], v[88:91], v[244:247], v[40:43]
    s_waitcnt vmcnt(3)
    buffer_load_dwordx4 v[92:95], v4, s[24:27], s52 offen offset:0 nt
    v_mfma_f32_16x16x32_bf16 v[44:47], v[88:91], v[248:251], v[44:47]
    buffer_load_dwordx4 v[96:99], v4, s[24:27], s52 offen offset:1280 nt
    buffer_load_dwordx4 v[100:103], v4, s[24:27], s52 offen offset:2560 nt
    buffer_load_dwordx4 v[104:107], v4, s[24:27], s52 offen offset:3840 nt
    buffer_load_dwordx4 v[108:111], v4, s[24:27], s64 offen offset:0 nt
    buffer_load_dwordx4 v[112:115], v4, s[24:27], s64 offen offset:1280 nt
    s_waitcnt vmcnt(8)
    v_mfma_f32_16x16x32_bf16 v[48:51], v[88:91], v[252:255], v[48:51]
    s_nop 7
    s_branch L_tail
L_cont8:
    ds_read_b128 v[20:23], v3 offset:2816
    ds_read_b128 v[24:27], v3 offset:2944
    ds_read_b128 v[28:31], v3 offset:3072
    ds_read_b32 v10, v9 offset:3200
    s_waitcnt vmcnt(3)
    buffer_load_dwordx4 v[180:183], v1, s[12:15], s80 offen offset:256 nt
    s_waitcnt lgkmcnt(0)
    v_mov_b32 v32, 0
    v_mov_b32 v33, 0
    v_dot2c_f32_bf16 v32, v40, v20
    v_dot2c_f32_bf16 v33, v52, v20
    v_dot2c_f32_bf16 v32, v41, v21
    v_dot2c_f32_bf16 v33, v53, v21
    v_dot2c_f32_bf16 v32, v42, v22
    v_dot2c_f32_bf16 v33, v54, v22
    v_dot2c_f32_bf16 v32, v43, v23
    v_dot2c_f32_bf16 v33, v55, v23
    v_dot2c_f32_bf16 v32, v44, v24
    v_dot2c_f32_bf16 v33, v56, v24
    v_dot2c_f32_bf16 v32, v45, v25
    v_dot2c_f32_bf16 v33, v57, v25
    v_dot2c_f32_bf16 v32, v46, v26
    v_dot2c_f32_bf16 v33, v58, v26
    v_dot2c_f32_bf16 v32, v47, v27
    v_dot2c_f32_bf16 v33, v59, v27
    v_dot2c_f32_bf16 v32, v48, v28
    v_dot2c_f32_bf16 v33, v60, v28
    v_dot2c_f32_bf16 v32, v49, v29
    v_dot2c_f32_bf16 v33, v61, v29
    v_dot2c_f32_bf16 v32, v50, v30
    v_dot2c_f32_bf16 v33, v62, v30
    v_dot2c_f32_bf16 v32, v51, v31
    v_dot2c_f32_bf16 v33, v63, v31
    s_nop 1
    v_add_f32_dpp v32, v32, v32 quad_perm:[1,0,3,2] row_mask:0xf bank_mask:0xf
    v_add_f32_dpp v33, v33, v33 quad_perm:[1,0,3,2] row_mask:0xf bank_mask:0xf
    s_nop 0
    v_add_f32_dpp v32, v32, v32 quad_perm:[2,3,0,1] row_mask:0xf bank_mask:0xf
    v_add_f32_dpp v33, v33, v33 quad_perm:[2,3,0,1] row_mask:0xf bank_mask:0xf
    s_nop 0
    v_add_f32_dpp v32, v32, v32 row_half_mirror row_mask:0xf bank_mask:0xf
    v_add_f32_dpp v33, v33, v33 row_half_mirror row_mask:0xf bank_mask:0xf
    v_cvt_pk_bf16_f32 v15, v32, v33
    v_lshlrev_b32 v32, 16, v15
    v_and_b32 v33, 0xffff0000, v15
    v_mul_f32 v32, 0x3d93cd3a, v32
    v_mul_f32 v33, 0x3d93cd3a, v33
    v_cvt_pk_bf16_f32 v15, v32, v33
    v_lshlrev_b32 v32, 16, v15
    v_and_b32 v33, 0xffff0000, v15
    s_waitcnt vmcnt(3)
    buffer_load_dwordx4 v[184:187], v1, s[12:15], s81 offen offset:0 nt
    v_mov_b32 v34, 0
    v_mov_b32 v35, 0
    v_dot2c_f32_bf16 v34, v64, v20
    v_dot2c_f32_bf16 v35, v76, v20
    v_dot2c_f32_bf16 v34, v65, v21
    v_dot2c_f32_bf16 v35, v77, v21
    v_dot2c_f32_bf16 v34, v66, v22
    v_dot2c_f32_bf16 v35, v78, v22
    v_dot2c_f32_bf16 v34, v67, v23
    v_dot2c_f32_bf16 v35, v79, v23
    v_dot2c_f32_bf16 v34, v68, v24
    v_dot2c_f32_bf16 v35, v80, v24
    v_dot2c_f32_bf16 v34, v69, v25
    v_dot2c_f32_bf16 v35, v81, v25
    v_dot2c_f32_bf16 v34, v70, v26
    v_dot2c_f32_bf16 v35, v82, v26
    v_dot2c_f32_bf16 v34, v71, v27
    v_dot2c_f32_bf16 v35, v83, v27
    v_dot2c_f32_bf16 v34, v72, v28
    v_dot2c_f32_bf16 v35, v84, v28
    v_dot2c_f32_bf16 v34, v73, v29
    v_dot2c_f32_bf16 v35, v85, v29
    v_dot2c_f32_bf16 v34, v74, v30
    v_dot2c_f32_bf16 v35, v86, v30
    v_dot2c_f32_bf16 v34, v75, v31
    v_dot2c_f32_bf16 v35, v87, v31
    s_nop 1
    v_add_f32_dpp v34, v34, v34 quad_perm:[1,0,3,2] row_mask:0xf bank_mask:0xf
    v_add_f32_dpp v35, v35, v35 quad_perm:[1,0,3,2] row_mask:0xf bank_mask:0xf
    s_nop 0
    v_add_f32_dpp v34, v34, v34 quad_perm:[2,3,0,1] row_mask:0xf bank_mask:0xf
    v_add_f32_dpp v35, v35, v35 quad_perm:[2,3,0,1] row_mask:0xf bank_mask:0xf
    s_nop 0
    v_add_f32_dpp v34, v34, v34 row_half_mirror row_mask:0xf bank_mask:0xf
    v_add_f32_dpp v35, v35, v35 row_half_mirror row_mask:0xf bank_mask:0xf
    v_cvt_pk_bf16_f32 v15, v34, v35
    v_lshlrev_b32 v34, 16, v15
    v_and_b32 v35, 0xffff0000, v15
    v_mul_f32 v34, 0x3d93cd3a, v34
    v_mul_f32 v35, 0x3d93cd3a, v35
    v_cvt_pk_bf16_f32 v15, v34, v35
    v_lshlrev_b32 v34, 16, v15
    v_and_b32 v35, 0xffff0000, v15
    s_waitcnt vmcnt(3)
    buffer_load_dwordx4 v[188:191], v1, s[12:15], s81 offen offset:128 nt
    v_mov_b32 v36, 0
    v_mov_b32 v37, 0
    v_dot2c_f32_bf16 v36, v88, v20
    v_dot2c_f32_bf16 v37, v100, v20
    v_dot2c_f32_bf16 v36, v89, v21
    v_dot2c_f32_bf16 v37, v101, v21
    v_dot2c_f32_bf16 v36, v90, v22
    v_dot2c_f32_bf16 v37, v102, v22
    v_dot2c_f32_bf16 v36, v91, v23
    v_dot2c_f32_bf16 v37, v103, v23
    v_dot2c_f32_bf16 v36, v92, v24
    v_dot2c_f32_bf16 v37, v104, v24
    v_dot2c_f32_bf16 v36, v93, v25
    v_dot2c_f32_bf16 v37, v105, v25
    v_dot2c_f32_bf16 v36, v94, v26
    v_dot2c_f32_bf16 v37, v106, v26
    v_dot2c_f32_bf16 v36, v95, v27
    v_dot2c_f32_bf16 v37, v107, v27
    v_dot2c_f32_bf16 v36, v96, v28
    v_dot2c_f32_bf16 v37, v108, v28
    v_dot2c_f32_bf16 v36, v97, v29
    v_dot2c_f32_bf16 v37, v109, v29
    v_dot2c_f32_bf16 v36, v98, v30
    v_dot2c_f32_bf16 v37, v110, v30
    v_dot2c_f32_bf16 v36, v99, v31
    v_dot2c_f32_bf16 v37, v111, v31
    s_nop 1
    v_add_f32_dpp v36, v36, v36 quad_perm:[1,0,3,2] row_mask:0xf bank_mask:0xf
    v_add_f32_dpp v37, v37, v37 quad_perm:[1,0,3,2] row_mask:0xf bank_mask:0xf
    s_nop 0
    v_add_f32_dpp v36, v36, v36 quad_perm:[2,3,0,1] row_mask:0xf bank_mask:0xf
    v_add_f32_dpp v37, v37, v37 quad_perm:[2,3,0,1] row_mask:0xf bank_mask:0xf
    s_nop 0
    v_add_f32_dpp v36, v36, v36 row_half_mirror row_mask:0xf bank_mask:0xf
    v_add_f32_dpp v37, v37, v37 row_half_mirror row_mask:0xf bank_mask:0xf
    v_cvt_pk_bf16_f32 v15, v36, v37
    v_lshlrev_b32 v36, 16, v15
    v_and_b32 v37, 0xffff0000, v15
    v_mul_f32 v36, 0x3d93cd3a, v36
    v_mul_f32 v37, 0x3d93cd3a, v37
    v_cvt_pk_bf16_f32 v15, v36, v37
    v_lshlrev_b32 v36, 16, v15
    v_and_b32 v37, 0xffff0000, v15
    s_waitcnt vmcnt(3)
    buffer_load_dwordx4 v[192:195], v1, s[12:15], s81 offen offset:256 nt
    v_mov_b32 v38, 0
    v_mov_b32 v39, 0
    v_dot2c_f32_bf16 v38, v112, v20
    v_dot2c_f32_bf16 v39, v124, v20
    v_dot2c_f32_bf16 v38, v113, v21
    v_dot2c_f32_bf16 v39, v125, v21
    v_dot2c_f32_bf16 v38, v114, v22
    v_dot2c_f32_bf16 v39, v126, v22
    v_dot2c_f32_bf16 v38, v115, v23
    v_dot2c_f32_bf16 v39, v127, v23
    v_dot2c_f32_bf16 v38, v116, v24
    v_dot2c_f32_bf16 v39, v128, v24
    v_dot2c_f32_bf16 v38, v117, v25
    v_dot2c_f32_bf16 v39, v129, v25
    v_dot2c_f32_bf16 v38, v118, v26
    v_dot2c_f32_bf16 v39, v130, v26
    v_dot2c_f32_bf16 v38, v119, v27
    v_dot2c_f32_bf16 v39, v131, v27
    v_dot2c_f32_bf16 v38, v120, v28
    v_dot2c_f32_bf16 v39, v132, v28
    v_dot2c_f32_bf16 v38, v121, v29
    v_dot2c_f32_bf16 v39, v133, v29
    v_dot2c_f32_bf16 v38, v122, v30
    v_dot2c_f32_bf16 v39, v134, v30
    v_dot2c_f32_bf16 v38, v123, v31
    v_dot2c_f32_bf16 v39, v135, v31
    s_nop 1
    v_add_f32_dpp v38, v38, v38 quad_perm:[1,0,3,2] row_mask:0xf bank_mask:0xf
    v_add_f32_dpp v39, v39, v39 quad_perm:[1,0,3,2] row_mask:0xf bank_mask:0xf
    s_nop 0
    v_add_f32_dpp v38, v38, v38 quad_perm:[2,3,0,1] row_mask:0xf bank_mask:0xf
    v_add_f32_dpp v39, v39, v39 quad_perm:[2,3,0,1] row_mask:0xf bank_mask:0xf
    s_nop 0
    v_add_f32_dpp v38, v38, v38 row_half_mirror row_mask:0xf bank_mask:0xf
    v_add_f32_dpp v39, v39, v39 row_half_mirror row_mask:0xf bank_mask:0xf
    v_cvt_pk_bf16_f32 v15, v38, v39
    v_lshlrev_b32 v38, 16, v15
    v_and_b32 v39, 0xffff0000, v15
    v_mul_f32 v38, 0x3d93cd3a, v38
    v_mul_f32 v39, 0x3d93cd3a, v39
    v_cvt_pk_bf16_f32 v15, v38, v39
    v_lshlrev_b32 v38, 16, v15
    v_and_b32 v39, 0xffff0000, v15
    s_waitcnt vmcnt(3)
    buffer_load_dwordx4 v[196:199], v1, s[12:15], s82 offen offset:0 nt
    v_mov_b32 v19, 0
    v_dot2c_f32_bf16 v19, v136, v20
    v_dot2c_f32_bf16 v19, v137, v21
    v_dot2c_f32_bf16 v19, v138, v22
    v_dot2c_f32_bf16 v19, v139, v23
    v_dot2c_f32_bf16 v19, v140, v24
    v_dot2c_f32_bf16 v19, v141, v25
    v_dot2c_f32_bf16 v19, v142, v26
    v_dot2c_f32_bf16 v19, v143, v27
    v_dot2c_f32_bf16 v19, v144, v28
    v_dot2c_f32_bf16 v19, v145, v29
    v_dot2c_f32_bf16 v19, v146, v30
    v_dot2c_f32_bf16 v19, v147, v31
    s_nop 2
    v_add_f32_dpp v19, v19, v19 quad_perm:[1,0,3,2] row_mask:0xf bank_mask:0xf
    s_nop 1
    v_add_f32_dpp v19, v19, v19 quad_perm:[2,3,0,1] row_mask:0xf bank_mask:0xf
    s_nop 1
    v_add_f32_dpp v19, v19, v19 row_half_mirror row_mask:0xf bank_mask:0xf
    v_cvt_pk_bf16_f32 v15, v19, v19
    v_lshlrev_b32 v19, 16, v15
    v_mul_f32 v19, 0x3d93cd3a, v19
    v_cvt_pk_bf16_f32 v15, v19, v19
    v_lshlrev_b32 v19, 16, v15
    s_waitcnt vmcnt(3)
    buffer_load_dwordx4 v[200:203], v1, s[12:15], s82 offen offset:128 nt
    v_mov_b32 v15, v32
    v_max3_f32 v15, v15, v33, v34
    v_max3_f32 v15, v15, v35, v36
    v_max3_f32 v15, v15, v37, v38
    v_max3_f32 v15, v15, v39, v19
    s_nop 1
    v_max_f32_dpp v15, v15, v15 row_ror:8 row_mask:0xf bank_mask:0xf
    v_mov_b32 v40, 0
    v_mov_b32 v41, 0
    v_mov_b32 v42, 0
    v_mov_b32 v43, 0
    v_mov_b32 v44, 0
    v_mov_b32 v45, 0
    v_mov_b32 v46, 0
    v_mov_b32 v47, 0
    v_mov_b32 v48, 0
    v_mov_b32 v49, 0
    v_mov_b32 v50, 0
    v_mov_b32 v51, 0
    v_mov_b32 v16, v15
    s_nop 1
    v_permlane16_swap_b32 v15, v16
    v_max_f32 v15, v15, v16
    v_mov_b32 v16, v15
    s_nop 1
    v_permlane32_swap_b32 v15, v16
    v_max_f32 v15, v15, v16
    v_mul_f32 v12, 0x3fb8aa3b, v15
    v_and_b32 v17, 1, v2
    v_lshlrev_b32 v17, 4, v17
    v_mov_b32 v18, 0xffff
    v_lshlrev_b32 v18, v17, v18
    v_bfe_u32 v17, v2, 1, 2
    v_cmp_eq_u32 vcc, 0, v17
    s_nop 1
    v_cndmask_b32 v52, 0, v18, vcc
    v_cmp_eq_u32 vcc, 1, v17
    s_nop 1
    v_cndmask_b32 v53, 0, v18, vcc
    v_cmp_eq_u32 vcc, 2, v17
    s_nop 1
    v_cndmask_b32 v54, 0, v18, vcc
    v_cmp_eq_u32 vcc, 3, v17
    s_nop 1
    v_cndmask_b32 v55, 0, v18, vcc
    s_waitcnt vmcnt(3)
    buffer_load_dwordx4 v[204:207], v1, s[12:15], s82 offen offset:256 nt
    s_mov_b32 s62, 0x3fb8aa3b
    v_fma_f32 v32, v32, s62, -v12
    v_fma_f32 v33, v33, s62, -v12
    v_fma_f32 v34, v34, s62, -v12
    v_fma_f32 v35, v35, s62, -v12
    v_fma_f32 v36, v36, s62, -v12
    v_fma_f32 v37, v37, s62, -v12
    v_fma_f32 v38, v38, s62, -v12
    v_fma_f32 v39, v39, s62, -v12
    v_fma_f32 v19, v19, s62, -v12
    v_exp_f32 v32, v32
    v_exp_f32 v33, v33
    v_exp_f32 v34, v34
    v_exp_f32 v35, v35
    v_exp_f32 v36, v36
    v_exp_f32 v37, v37
    v_exp_f32 v38, v38
    v_exp_f32 v39, v39
    v_exp_f32 v19, v19
    v_cvt_pk_bf16_f32 v32, v32, v32
    v_cvt_pk_bf16_f32 v33, v33, v33
    v_cvt_pk_bf16_f32 v34, v34, v34
    v_cvt_pk_bf16_f32 v35, v35, v35
    v_cvt_pk_bf16_f32 v36, v36, v36
    v_cvt_pk_bf16_f32 v37, v37, v37
    v_cvt_pk_bf16_f32 v38, v38, v38
    v_cvt_pk_bf16_f32 v39, v39, v39
    v_cvt_pk_bf16_f32 v19, v19, v19
    s_waitcnt vmcnt(3)
    buffer_load_dwordx4 v[208:211], v1, s[12:15], s83 offen offset:0 nt
    v_and_b32 v56, v52, v32
    v_and_b32 v57, v53, v32
    v_and_b32 v58, v54, v32
    v_and_b32 v59, v55, v32
    v_and_b32 v60, v52, v33
    v_and_b32 v61, v53, v33
    v_and_b32 v62, v54, v33
    v_and_b32 v63, v55, v33
    v_and_b32 v64, v52, v34
    v_and_b32 v65, v53, v34
    v_and_b32 v66, v54, v34
    v_and_b32 v67, v55, v34
    v_and_b32 v68, v52, v35
    v_and_b32 v69, v53, v35
    v_and_b32 v70, v54, v35
    v_and_b32 v71, v55, v35
    v_and_b32 v72, v52, v36
    v_and_b32 v73, v53, v36
    v_and_b32 v74, v54, v36
    v_and_b32 v75, v55, v36
    v_and_b32 v76, v52, v37
    v_and_b32 v77, v53, v37
    v_and_b32 v78, v54, v37
    v_and_b32 v79, v55, v37
    v_and_b32 v80, v52, v38
    v_and_b32 v81, v53, v38
    v_and_b32 v82, v54, v38
    v_and_b32 v83, v55, v38
    v_and_b32 v84, v52, v39
    v_and_b32 v85, v53, v39
    v_and_b32 v86, v54, v39
    v_and_b32 v87, v55, v39
    v_and_b32 v88, v52, v19
    v_and_b32 v89, v53, v19
    v_and_b32 v90, v54, v19
    v_and_b32 v91, v55, v19
    s_waitcnt vmcnt(3)
    buffer_load_dwordx4 v[212:215], v1, s[12:15], s83 offen offset:128 nt
    v_and_b32 v13, 0xffff0000, v32
    v_and_b32 v15, 0xffff0000, v33
    v_add_f32 v13, v13, v15
    v_and_b32 v15, 0xffff0000, v34
    v_add_f32 v13, v13, v15
    v_and_b32 v15, 0xffff0000, v35
    v_add_f32 v13, v13, v15
    v_and_b32 v15, 0xffff0000, v36
    v_add_f32 v13, v13, v15
    v_and_b32 v15, 0xffff0000, v37
    v_add_f32 v13, v13, v15
    v_and_b32 v15, 0xffff0000, v38
    v_add_f32 v13, v13, v15
    v_and_b32 v15, 0xffff0000, v39
    v_add_f32 v13, v13, v15
    v_and_b32 v15, 0xffff0000, v19
    v_add_f32 v13, v13, v15
    s_nop 1
    v_add_f32_dpp v13, v13, v13 row_ror:8 row_mask:0xf bank_mask:0xf
    v_mov_b32 v16, v13
    s_nop 1
    v_permlane16_swap_b32 v13, v16
    v_add_f32 v13, v13, v16
    v_mov_b32 v16, v13
    s_nop 1
    v_permlane32_swap_b32 v13, v16
    v_add_f32 v13, v13, v16
    s_lshl_b32 s62, s3, 3
    v_mov_b32 v16, s62
    ds_write_b64 v16, v[12:13] offset:3584
    s_waitcnt vmcnt(3)
    buffer_load_dwordx4 v[216:219], v1, s[12:15], s83 offen offset:256 nt
    v_mfma_f32_16x16x32_bf16 v[40:43], v[56:59], v[148:151], v[40:43]
    v_mfma_f32_16x16x32_bf16 v[44:47], v[56:59], v[152:155], v[44:47]
    v_mfma_f32_16x16x32_bf16 v[48:51], v[56:59], v[156:159], v[48:51]
    v_mfma_f32_16x16x32_bf16 v[40:43], v[60:63], v[160:163], v[40:43]
    v_mfma_f32_16x16x32_bf16 v[44:47], v[60:63], v[164:167], v[44:47]
    v_mfma_f32_16x16x32_bf16 v[48:51], v[60:63], v[168:171], v[48:51]
    v_mfma_f32_16x16x32_bf16 v[40:43], v[64:67], v[172:175], v[40:43]
    v_mfma_f32_16x16x32_bf16 v[44:47], v[64:67], v[176:179], v[44:47]
    s_waitcnt vmcnt(3)
    buffer_load_dwordx4 v[220:223], v1, s[12:15], s84 offen offset:0 nt
    v_mfma_f32_16x16x32_bf16 v[48:51], v[64:67], v[180:183], v[48:51]
    v_mfma_f32_16x16x32_bf16 v[40:43], v[68:71], v[184:187], v[40:43]
    v_mfma_f32_16x16x32_bf16 v[44:47], v[68:71], v[188:191], v[44:47]
    v_mfma_f32_16x16x32_bf16 v[48:51], v[68:71], v[192:195], v[48:51]
    v_mfma_f32_16x16x32_bf16 v[40:43], v[72:75], v[196:199], v[40:43]
    v_mfma_f32_16x16x32_bf16 v[44:47], v[72:75], v[200:203], v[44:47]
    v_mfma_f32_16x16x32_bf16 v[48:51], v[72:75], v[204:207], v[48:51]
    s_waitcnt vmcnt(3)
    buffer_load_dwordx4 v[224:227], v1, s[12:15], s84 offen offset:128 nt
    v_mfma_f32_16x16x32_bf16 v[40:43], v[76:79], v[208:211], v[40:43]
    s_waitcnt vmcnt(3)
    buffer_load_dwordx4 v[228:231], v1, s[12:15], s84 offen offset:256 nt
    v_mfma_f32_16x16x32_bf16 v[44:47], v[76:79], v[212:215], v[44:47]
    s_waitcnt vmcnt(3)
    buffer_load_dwordx4 v[232:235], v1, s[12:15], s85 offen offset:0 nt
    v_mfma_f32_16x16x32_bf16 v[48:51], v[76:79], v[216:219], v[48:51]
    s_waitcnt vmcnt(3)
    buffer_load_dwordx4 v[236:239], v1, s[12:15], s85 offen offset:128 nt
    v_mfma_f32_16x16x32_bf16 v[40:43], v[80:83], v[220:223], v[40:43]
    s_waitcnt vmcnt(3)
    buffer_load_dwordx4 v[240:243], v1, s[12:15], s85 offen offset:256 nt
    v_mfma_f32_16x16x32_bf16 v[44:47], v[80:83], v[224:227], v[44:47]
    s_waitcnt vmcnt(3)
    buffer_load_dwordx4 v[244:247], v1, s[12:15], s86 offen offset:0 nt
    v_mfma_f32_16x16x32_bf16 v[48:51], v[80:83], v[228:231], v[48:51]
    s_waitcnt vmcnt(3)
    buffer_load_dwordx4 v[248:251], v1, s[12:15], s86 offen offset:128 nt
    v_mfma_f32_16x16x32_bf16 v[40:43], v[84:87], v[232:235], v[40:43]
    s_waitcnt vmcnt(3)
    buffer_load_dwordx4 v[252:255], v1, s[12:15], s86 offen offset:256 nt
    v_mfma_f32_16x16x32_bf16 v[44:47], v[84:87], v[236:239], v[44:47]
    s_waitcnt vmcnt(3)
    buffer_load_dwordx4 v[116:119], v5, s[36:39], s53 offen offset:0 nt
    v_mfma_f32_16x16x32_bf16 v[48:51], v[84:87], v[240:243], v[48:51]
    s_waitcnt vmcnt(3)
    buffer_load_dwordx4 v[120:123], v5, s[36:39], s53 offen offset:1280 nt
    v_mfma_f32_16x16x32_bf16 v[40:43], v[88:91], v[244:247], v[40:43]
    s_waitcnt vmcnt(3)
    buffer_load_dwordx4 v[92:95], v4, s[24:27], s52 offen offset:0 nt
    v_mfma_f32_16x16x32_bf16 v[44:47], v[88:91], v[248:251], v[44:47]
    buffer_load_dwordx4 v[96:99], v4, s[24:27], s52 offen offset:1280 nt
    buffer_load_dwordx4 v[100:103], v4, s[24:27], s52 offen offset:2560 nt
    buffer_load_dwordx4 v[104:107], v4, s[24:27], s52 offen offset:3840 nt
    buffer_load_dwordx4 v[108:111], v4, s[24:27], s64 offen offset:0 nt
    buffer_load_dwordx4 v[112:115], v4, s[24:27], s64 offen offset:1280 nt
    s_waitcnt vmcnt(8)
    v_mfma_f32_16x16x32_bf16 v[48:51], v[88:91], v[252:255], v[48:51]
    s_nop 7
    s_branch L_tail
L_cont11:
    ds_read_b128 v[20:23], v3 offset:2816
    ds_read_b128 v[24:27], v3 offset:2944
    ds_read_b128 v[28:31], v3 offset:3072
    ds_read_b32 v10, v9 offset:3200
    s_waitcnt vmcnt(3)
    buffer_load_dwordx4 v[192:195], v1, s[12:15], s81 offen offset:256 nt
    s_waitcnt lgkmcnt(0)
    v_mov_b32 v32, 0
    v_mov_b32 v33, 0
    v_dot2c_f32_bf16 v32, v40, v20
    v_dot2c_f32_bf16 v33, v52, v20
    v_dot2c_f32_bf16 v32, v41, v21
    v_dot2c_f32_bf16 v33, v53, v21
    v_dot2c_f32_bf16 v32, v42, v22
    v_dot2c_f32_bf16 v33, v54, v22
    v_dot2c_f32_bf16 v32, v43, v23
    v_dot2c_f32_bf16 v33, v55, v23
    v_dot2c_f32_bf16 v32, v44, v24
    v_dot2c_f32_bf16 v33, v56, v24
    v_dot2c_f32_bf16 v32, v45, v25
    v_dot2c_f32_bf16 v33, v57, v25
    v_dot2c_f32_bf16 v32, v46, v26
    v_dot2c_f32_bf16 v33, v58, v26
    v_dot2c_f32_bf16 v32, v47, v27
    v_dot2c_f32_bf16 v33, v59, v27
    v_dot2c_f32_bf16 v32, v48, v28
    v_dot2c_f32_bf16 v33, v60, v28
    v_dot2c_f32_bf16 v32, v49, v29
    v_dot2c_f32_bf16 v33, v61, v29
    v_dot2c_f32_bf16 v32, v50, v30
    v_dot2c_f32_bf16 v33, v62, v30
    v_dot2c_f32_bf16 v32, v51, v31
    v_dot2c_f32_bf16 v33, v63, v31
    s_nop 1
    v_add_f32_dpp v32, v32, v32 quad_perm:[1,0,3,2] row_mask:0xf bank_mask:0xf
    v_add_f32_dpp v33, v33, v33 quad_perm:[1,0,3,2] row_mask:0xf bank_mask:0xf
    s_nop 0
    v_add_f32_dpp v32, v32, v32 quad_perm:[2,3,0,1] row_mask:0xf bank_mask:0xf
    v_add_f32_dpp v33, v33, v33 quad_perm:[2,3,0,1] row_mask:0xf bank_mask:0xf
    s_nop 0
    v_add_f32_dpp v32, v32, v32 row_half_mirror row_mask:0xf bank_mask:0xf
    v_add_f32_dpp v33, v33, v33 row_half_mirror row_mask:0xf bank_mask:0xf
    v_cvt_pk_bf16_f32 v15, v32, v33
    v_lshlrev_b32 v32, 16, v15
    v_and_b32 v33, 0xffff0000, v15
    v_mul_f32 v32, 0x3d93cd3a, v32
    v_mul_f32 v33, 0x3d93cd3a, v33
    v_cvt_pk_bf16_f32 v15, v32, v33
    v_lshlrev_b32 v32, 16, v15
    v_and_b32 v33, 0xffff0000, v15
    s_waitcnt vmcnt(3)
    buffer_load_dwordx4 v[196:199], v1, s[12:15], s82 offen offset:0 nt
    v_mov_b32 v34, 0
    v_mov_b32 v35, 0
    v_dot2c_f32_bf16 v34, v64, v20
    v_dot2c_f32_bf16 v35, v76, v20
    v_dot2c_f32_bf16 v34, v65, v21
    v_dot2c_f32_bf16 v35, v77, v21
    v_dot2c_f32_bf16 v34, v66, v22
    v_dot2c_f32_bf16 v35, v78, v22
    v_dot2c_f32_bf16 v34, v67, v23
    v_dot2c_f32_bf16 v35, v79, v23
    v_dot2c_f32_bf16 v34, v68, v24
    v_dot2c_f32_bf16 v35, v80, v24
    v_dot2c_f32_bf16 v34, v69, v25
    v_dot2c_f32_bf16 v35, v81, v25
    v_dot2c_f32_bf16 v34, v70, v26
    v_dot2c_f32_bf16 v35, v82, v26
    v_dot2c_f32_bf16 v34, v71, v27
    v_dot2c_f32_bf16 v35, v83, v27
    v_dot2c_f32_bf16 v34, v72, v28
    v_dot2c_f32_bf16 v35, v84, v28
    v_dot2c_f32_bf16 v34, v73, v29
    v_dot2c_f32_bf16 v35, v85, v29
    v_dot2c_f32_bf16 v34, v74, v30
    v_dot2c_f32_bf16 v35, v86, v30
    v_dot2c_f32_bf16 v34, v75, v31
    v_dot2c_f32_bf16 v35, v87, v31
    s_nop 1
    v_add_f32_dpp v34, v34, v34 quad_perm:[1,0,3,2] row_mask:0xf bank_mask:0xf
    v_add_f32_dpp v35, v35, v35 quad_perm:[1,0,3,2] row_mask:0xf bank_mask:0xf
    s_nop 0
    v_add_f32_dpp v34, v34, v34 quad_perm:[2,3,0,1] row_mask:0xf bank_mask:0xf
    v_add_f32_dpp v35, v35, v35 quad_perm:[2,3,0,1] row_mask:0xf bank_mask:0xf
    s_nop 0
    v_add_f32_dpp v34, v34, v34 row_half_mirror row_mask:0xf bank_mask:0xf
    v_add_f32_dpp v35, v35, v35 row_half_mirror row_mask:0xf bank_mask:0xf
    v_cvt_pk_bf16_f32 v15, v34, v35
    v_lshlrev_b32 v34, 16, v15
    v_and_b32 v35, 0xffff0000, v15
    v_mul_f32 v34, 0x3d93cd3a, v34
    v_mul_f32 v35, 0x3d93cd3a, v35
    v_cvt_pk_bf16_f32 v15, v34, v35
    v_lshlrev_b32 v34, 16, v15
    v_and_b32 v35, 0xffff0000, v15
    s_waitcnt vmcnt(3)
    buffer_load_dwordx4 v[200:203], v1, s[12:15], s82 offen offset:128 nt
    v_mov_b32 v36, 0
    v_mov_b32 v37, 0
    v_dot2c_f32_bf16 v36, v88, v20
    v_dot2c_f32_bf16 v37, v100, v20
    v_dot2c_f32_bf16 v36, v89, v21
    v_dot2c_f32_bf16 v37, v101, v21
    v_dot2c_f32_bf16 v36, v90, v22
    v_dot2c_f32_bf16 v37, v102, v22
    v_dot2c_f32_bf16 v36, v91, v23
    v_dot2c_f32_bf16 v37, v103, v23
    v_dot2c_f32_bf16 v36, v92, v24
    v_dot2c_f32_bf16 v37, v104, v24
    v_dot2c_f32_bf16 v36, v93, v25
    v_dot2c_f32_bf16 v37, v105, v25
    v_dot2c_f32_bf16 v36, v94, v26
    v_dot2c_f32_bf16 v37, v106, v26
    v_dot2c_f32_bf16 v36, v95, v27
    v_dot2c_f32_bf16 v37, v107, v27
    v_dot2c_f32_bf16 v36, v96, v28
    v_dot2c_f32_bf16 v37, v108, v28
    v_dot2c_f32_bf16 v36, v97, v29
    v_dot2c_f32_bf16 v37, v109, v29
    v_dot2c_f32_bf16 v36, v98, v30
    v_dot2c_f32_bf16 v37, v110, v30
    v_dot2c_f32_bf16 v36, v99, v31
    v_dot2c_f32_bf16 v37, v111, v31
    s_nop 1
    v_add_f32_dpp v36, v36, v36 quad_perm:[1,0,3,2] row_mask:0xf bank_mask:0xf
    v_add_f32_dpp v37, v37, v37 quad_perm:[1,0,3,2] row_mask:0xf bank_mask:0xf
    s_nop 0
    v_add_f32_dpp v36, v36, v36 quad_perm:[2,3,0,1] row_mask:0xf bank_mask:0xf
    v_add_f32_dpp v37, v37, v37 quad_perm:[2,3,0,1] row_mask:0xf bank_mask:0xf
    s_nop 0
    v_add_f32_dpp v36, v36, v36 row_half_mirror row_mask:0xf bank_mask:0xf
    v_add_f32_dpp v37, v37, v37 row_half_mirror row_mask:0xf bank_mask:0xf
    v_cvt_pk_bf16_f32 v15, v36, v37
    v_lshlrev_b32 v36, 16, v15
    v_and_b32 v37, 0xffff0000, v15
    v_mul_f32 v36, 0x3d93cd3a, v36
    v_mul_f32 v37, 0x3d93cd3a, v37
    v_cvt_pk_bf16_f32 v15, v36, v37
    v_lshlrev_b32 v36, 16, v15
    v_and_b32 v37, 0xffff0000, v15
    s_waitcnt vmcnt(3)
    buffer_load_dwordx4 v[204:207], v1, s[12:15], s82 offen offset:256 nt
    v_mov_b32 v38, 0
    v_mov_b32 v39, 0
    v_dot2c_f32_bf16 v38, v112, v20
    v_dot2c_f32_bf16 v39, v124, v20
    v_dot2c_f32_bf16 v38, v113, v21
    v_dot2c_f32_bf16 v39, v125, v21
    v_dot2c_f32_bf16 v38, v114, v22
    v_dot2c_f32_bf16 v39, v126, v22
    v_dot2c_f32_bf16 v38, v115, v23
    v_dot2c_f32_bf16 v39, v127, v23
    v_dot2c_f32_bf16 v38, v116, v24
    v_dot2c_f32_bf16 v39, v128, v24
    v_dot2c_f32_bf16 v38, v117, v25
    v_dot2c_f32_bf16 v39, v129, v25
    v_dot2c_f32_bf16 v38, v118, v26
    v_dot2c_f32_bf16 v39, v130, v26
    v_dot2c_f32_bf16 v38, v119, v27
    v_dot2c_f32_bf16 v39, v131, v27
    v_dot2c_f32_bf16 v38, v120, v28
    v_dot2c_f32_bf16 v39, v132, v28
    v_dot2c_f32_bf16 v38, v121, v29
    v_dot2c_f32_bf16 v39, v133, v29
    v_dot2c_f32_bf16 v38, v122, v30
    v_dot2c_f32_bf16 v39, v134, v30
    v_dot2c_f32_bf16 v38, v123, v31
    v_dot2c_f32_bf16 v39, v135, v31
    s_nop 1
    v_add_f32_dpp v38, v38, v38 quad_perm:[1,0,3,2] row_mask:0xf bank_mask:0xf
    v_add_f32_dpp v39, v39, v39 quad_perm:[1,0,3,2] row_mask:0xf bank_mask:0xf
    s_nop 0
    v_add_f32_dpp v38, v38, v38 quad_perm:[2,3,0,1] row_mask:0xf bank_mask:0xf
    v_add_f32_dpp v39, v39, v39 quad_perm:[2,3,0,1] row_mask:0xf bank_mask:0xf
    s_nop 0
    v_add_f32_dpp v38, v38, v38 row_half_mirror row_mask:0xf bank_mask:0xf
    v_add_f32_dpp v39, v39, v39 row_half_mirror row_mask:0xf bank_mask:0xf
    v_cvt_pk_bf16_f32 v15, v38, v39
    v_lshlrev_b32 v38, 16, v15
    v_and_b32 v39, 0xffff0000, v15
    v_mul_f32 v38, 0x3d93cd3a, v38
    v_mul_f32 v39, 0x3d93cd3a, v39
    v_cvt_pk_bf16_f32 v15, v38, v39
    v_lshlrev_b32 v38, 16, v15
    v_and_b32 v39, 0xffff0000, v15
    s_waitcnt vmcnt(3)
    buffer_load_dwordx4 v[208:211], v1, s[12:15], s83 offen offset:0 nt
    v_mov_b32 v19, 0
    v_dot2c_f32_bf16 v19, v136, v20
    v_dot2c_f32_bf16 v19, v137, v21
    v_dot2c_f32_bf16 v19, v138, v22
    v_dot2c_f32_bf16 v19, v139, v23
    v_dot2c_f32_bf16 v19, v140, v24
    v_dot2c_f32_bf16 v19, v141, v25
    v_dot2c_f32_bf16 v19, v142, v26
    v_dot2c_f32_bf16 v19, v143, v27
    v_dot2c_f32_bf16 v19, v144, v28
    v_dot2c_f32_bf16 v19, v145, v29
    v_dot2c_f32_bf16 v19, v146, v30
    v_dot2c_f32_bf16 v19, v147, v31
    s_nop 2
    v_add_f32_dpp v19, v19, v19 quad_perm:[1,0,3,2] row_mask:0xf bank_mask:0xf
    s_nop 1
    v_add_f32_dpp v19, v19, v19 quad_perm:[2,3,0,1] row_mask:0xf bank_mask:0xf
    s_nop 1
    v_add_f32_dpp v19, v19, v19 row_half_mirror row_mask:0xf bank_mask:0xf
    v_cvt_pk_bf16_f32 v15, v19, v19
    v_lshlrev_b32 v19, 16, v15
    v_mul_f32 v19, 0x3d93cd3a, v19
    v_cvt_pk_bf16_f32 v15, v19, v19
    v_lshlrev_b32 v19, 16, v15
    s_waitcnt vmcnt(3)
    buffer_load_dwordx4 v[212:215], v1, s[12:15], s83 offen offset:128 nt
    v_mov_b32 v15, v32
    v_max3_f32 v15, v15, v33, v34
    v_max3_f32 v15, v15, v35, v36
    v_max3_f32 v15, v15, v37, v38
    v_max3_f32 v15, v15, v39, v19
    s_nop 1
    v_max_f32_dpp v15, v15, v15 row_ror:8 row_mask:0xf bank_mask:0xf
    v_mov_b32 v40, 0
    v_mov_b32 v41, 0
    v_mov_b32 v42, 0
    v_mov_b32 v43, 0
    v_mov_b32 v44, 0
    v_mov_b32 v45, 0
    v_mov_b32 v46, 0
    v_mov_b32 v47, 0
    v_mov_b32 v48, 0
    v_mov_b32 v49, 0
    v_mov_b32 v50, 0
    v_mov_b32 v51, 0
    v_mov_b32 v16, v15
    s_nop 1
    v_permlane16_swap_b32 v15, v16
    v_max_f32 v15, v15, v16
    v_mov_b32 v16, v15
    s_nop 1
    v_permlane32_swap_b32 v15, v16
    v_max_f32 v15, v15, v16
    v_mul_f32 v12, 0x3fb8aa3b, v15
    v_and_b32 v17, 1, v2
    v_lshlrev_b32 v17, 4, v17
    v_mov_b32 v18, 0xffff
    v_lshlrev_b32 v18, v17, v18
    v_bfe_u32 v17, v2, 1, 2
    v_cmp_eq_u32 vcc, 0, v17
    s_nop 1
    v_cndmask_b32 v52, 0, v18, vcc
    v_cmp_eq_u32 vcc, 1, v17
    s_nop 1
    v_cndmask_b32 v53, 0, v18, vcc
    v_cmp_eq_u32 vcc, 2, v17
    s_nop 1
    v_cndmask_b32 v54, 0, v18, vcc
    v_cmp_eq_u32 vcc, 3, v17
    s_nop 1
    v_cndmask_b32 v55, 0, v18, vcc
    s_waitcnt vmcnt(3)
    buffer_load_dwordx4 v[216:219], v1, s[12:15], s83 offen offset:256 nt
    s_mov_b32 s62, 0x3fb8aa3b
    v_fma_f32 v32, v32, s62, -v12
    v_fma_f32 v33, v33, s62, -v12
    v_fma_f32 v34, v34, s62, -v12
    v_fma_f32 v35, v35, s62, -v12
    v_fma_f32 v36, v36, s62, -v12
    v_fma_f32 v37, v37, s62, -v12
    v_fma_f32 v38, v38, s62, -v12
    v_fma_f32 v39, v39, s62, -v12
    v_fma_f32 v19, v19, s62, -v12
    v_exp_f32 v32, v32
    v_exp_f32 v33, v33
    v_exp_f32 v34, v34
    v_exp_f32 v35, v35
    v_exp_f32 v36, v36
    v_exp_f32 v37, v37
    v_exp_f32 v38, v38
    v_exp_f32 v39, v39
    v_exp_f32 v19, v19
    v_cvt_pk_bf16_f32 v32, v32, v32
    v_cvt_pk_bf16_f32 v33, v33, v33
    v_cvt_pk_bf16_f32 v34, v34, v34
    v_cvt_pk_bf16_f32 v35, v35, v35
    v_cvt_pk_bf16_f32 v36, v36, v36
    v_cvt_pk_bf16_f32 v37, v37, v37
    v_cvt_pk_bf16_f32 v38, v38, v38
    v_cvt_pk_bf16_f32 v39, v39, v39
    v_cvt_pk_bf16_f32 v19, v19, v19
    s_waitcnt vmcnt(3)
    buffer_load_dwordx4 v[220:223], v1, s[12:15], s84 offen offset:0 nt
    v_and_b32 v56, v52, v32
    v_and_b32 v57, v53, v32
    v_and_b32 v58, v54, v32
    v_and_b32 v59, v55, v32
    v_and_b32 v60, v52, v33
    v_and_b32 v61, v53, v33
    v_and_b32 v62, v54, v33
    v_and_b32 v63, v55, v33
    v_and_b32 v64, v52, v34
    v_and_b32 v65, v53, v34
    v_and_b32 v66, v54, v34
    v_and_b32 v67, v55, v34
    v_and_b32 v68, v52, v35
    v_and_b32 v69, v53, v35
    v_and_b32 v70, v54, v35
    v_and_b32 v71, v55, v35
    v_and_b32 v72, v52, v36
    v_and_b32 v73, v53, v36
    v_and_b32 v74, v54, v36
    v_and_b32 v75, v55, v36
    v_and_b32 v76, v52, v37
    v_and_b32 v77, v53, v37
    v_and_b32 v78, v54, v37
    v_and_b32 v79, v55, v37
    v_and_b32 v80, v52, v38
    v_and_b32 v81, v53, v38
    v_and_b32 v82, v54, v38
    v_and_b32 v83, v55, v38
    v_and_b32 v84, v52, v39
    v_and_b32 v85, v53, v39
    v_and_b32 v86, v54, v39
    v_and_b32 v87, v55, v39
    v_and_b32 v88, v52, v19
    v_and_b32 v89, v53, v19
    v_and_b32 v90, v54, v19
    v_and_b32 v91, v55, v19
    s_waitcnt vmcnt(3)
    buffer_load_dwordx4 v[224:227], v1, s[12:15], s84 offen offset:128 nt
    v_and_b32 v13, 0xffff0000, v32
    v_and_b32 v15, 0xffff0000, v33
    v_add_f32 v13, v13, v15
    v_and_b32 v15, 0xffff0000, v34
    v_add_f32 v13, v13, v15
    v_and_b32 v15, 0xffff0000, v35
    v_add_f32 v13, v13, v15
    v_and_b32 v15, 0xffff0000, v36
    v_add_f32 v13, v13, v15
    v_and_b32 v15, 0xffff0000, v37
    v_add_f32 v13, v13, v15
    v_and_b32 v15, 0xffff0000, v38
    v_add_f32 v13, v13, v15
    v_and_b32 v15, 0xffff0000, v39
    v_add_f32 v13, v13, v15
    v_and_b32 v15, 0xffff0000, v19
    v_add_f32 v13, v13, v15
    s_nop 1
    v_add_f32_dpp v13, v13, v13 row_ror:8 row_mask:0xf bank_mask:0xf
    v_mov_b32 v16, v13
    s_nop 1
    v_permlane16_swap_b32 v13, v16
    v_add_f32 v13, v13, v16
    v_mov_b32 v16, v13
    s_nop 1
    v_permlane32_swap_b32 v13, v16
    v_add_f32 v13, v13, v16
    s_lshl_b32 s62, s3, 3
    v_mov_b32 v16, s62
    ds_write_b64 v16, v[12:13] offset:3584
    s_waitcnt vmcnt(3)
    buffer_load_dwordx4 v[228:231], v1, s[12:15], s84 offen offset:256 nt
    v_mfma_f32_16x16x32_bf16 v[40:43], v[56:59], v[148:151], v[40:43]
    v_mfma_f32_16x16x32_bf16 v[44:47], v[56:59], v[152:155], v[44:47]
    v_mfma_f32_16x16x32_bf16 v[48:51], v[56:59], v[156:159], v[48:51]
    v_mfma_f32_16x16x32_bf16 v[40:43], v[60:63], v[160:163], v[40:43]
    v_mfma_f32_16x16x32_bf16 v[44:47], v[60:63], v[164:167], v[44:47]
    v_mfma_f32_16x16x32_bf16 v[48:51], v[60:63], v[168:171], v[48:51]
    v_mfma_f32_16x16x32_bf16 v[40:43], v[64:67], v[172:175], v[40:43]
    v_mfma_f32_16x16x32_bf16 v[44:47], v[64:67], v[176:179], v[44:47]
    s_waitcnt vmcnt(3)
    buffer_load_dwordx4 v[232:235], v1, s[12:15], s85 offen offset:0 nt
    v_mfma_f32_16x16x32_bf16 v[48:51], v[64:67], v[180:183], v[48:51]
    v_mfma_f32_16x16x32_bf16 v[40:43], v[68:71], v[184:187], v[40:43]
    v_mfma_f32_16x16x32_bf16 v[44:47], v[68:71], v[188:191], v[44:47]
    v_mfma_f32_16x16x32_bf16 v[48:51], v[68:71], v[192:195], v[48:51]
    v_mfma_f32_16x16x32_bf16 v[40:43], v[72:75], v[196:199], v[40:43]
    v_mfma_f32_16x16x32_bf16 v[44:47], v[72:75], v[200:203], v[44:47]
    v_mfma_f32_16x16x32_bf16 v[48:51], v[72:75], v[204:207], v[48:51]
    v_mfma_f32_16x16x32_bf16 v[40:43], v[76:79], v[208:211], v[40:43]
    s_waitcnt vmcnt(3)
    buffer_load_dwordx4 v[236:239], v1, s[12:15], s85 offen offset:128 nt
    v_mfma_f32_16x16x32_bf16 v[44:47], v[76:79], v[212:215], v[44:47]
    v_mfma_f32_16x16x32_bf16 v[48:51], v[76:79], v[216:219], v[48:51]
    v_mfma_f32_16x16x32_bf16 v[40:43], v[80:83], v[220:223], v[40:43]
    s_waitcnt vmcnt(3)
    buffer_load_dwordx4 v[240:243], v1, s[12:15], s85 offen offset:256 nt
    v_mfma_f32_16x16x32_bf16 v[44:47], v[80:83], v[224:227], v[44:47]
    s_waitcnt vmcnt(3)
    buffer_load_dwordx4 v[244:247], v1, s[12:15], s86 offen offset:0 nt
    v_mfma_f32_16x16x32_bf16 v[48:51], v[80:83], v[228:231], v[48:51]
    s_waitcnt vmcnt(3)
    buffer_load_dwordx4 v[248:251], v1, s[12:15], s86 offen offset:128 nt
    v_mfma_f32_16x16x32_bf16 v[40:43], v[84:87], v[232:235], v[40:43]
    s_waitcnt vmcnt(3)
    buffer_load_dwordx4 v[252:255], v1, s[12:15], s86 offen offset:256 nt
    v_mfma_f32_16x16x32_bf16 v[44:47], v[84:87], v[236:239], v[44:47]
    s_waitcnt vmcnt(3)
    buffer_load_dwordx4 v[116:119], v5, s[36:39], s53 offen offset:0 nt
    v_mfma_f32_16x16x32_bf16 v[48:51], v[84:87], v[240:243], v[48:51]
    s_waitcnt vmcnt(3)
    buffer_load_dwordx4 v[120:123], v5, s[36:39], s53 offen offset:1280 nt
    v_mfma_f32_16x16x32_bf16 v[40:43], v[88:91], v[244:247], v[40:43]
    s_waitcnt vmcnt(3)
    buffer_load_dwordx4 v[92:95], v4, s[24:27], s52 offen offset:0 nt
    v_mfma_f32_16x16x32_bf16 v[44:47], v[88:91], v[248:251], v[44:47]
    buffer_load_dwordx4 v[96:99], v4, s[24:27], s52 offen offset:1280 nt
    buffer_load_dwordx4 v[100:103], v4, s[24:27], s52 offen offset:2560 nt
    buffer_load_dwordx4 v[104:107], v4, s[24:27], s52 offen offset:3840 nt
    buffer_load_dwordx4 v[108:111], v4, s[24:27], s64 offen offset:0 nt
    buffer_load_dwordx4 v[112:115], v4, s[24:27], s64 offen offset:1280 nt
    s_waitcnt vmcnt(8)
    v_mfma_f32_16x16x32_bf16 v[48:51], v[88:91], v[252:255], v[48:51]
    s_nop 7
    s_branch L_tail
L_cont14:
    ds_read_b128 v[20:23], v3 offset:2816
    ds_read_b128 v[24:27], v3 offset:2944
    ds_read_b128 v[28:31], v3 offset:3072
    ds_read_b32 v10, v9 offset:3200
    s_waitcnt vmcnt(3)
    buffer_load_dwordx4 v[204:207], v1, s[12:15], s82 offen offset:256 nt
    s_waitcnt lgkmcnt(0)
    v_mov_b32 v32, 0
    v_mov_b32 v33, 0
    v_dot2c_f32_bf16 v32, v40, v20
    v_dot2c_f32_bf16 v33, v52, v20
    v_dot2c_f32_bf16 v32, v41, v21
    v_dot2c_f32_bf16 v33, v53, v21
    v_dot2c_f32_bf16 v32, v42, v22
    v_dot2c_f32_bf16 v33, v54, v22
    v_dot2c_f32_bf16 v32, v43, v23
    v_dot2c_f32_bf16 v33, v55, v23
    v_dot2c_f32_bf16 v32, v44, v24
    v_dot2c_f32_bf16 v33, v56, v24
    v_dot2c_f32_bf16 v32, v45, v25
    v_dot2c_f32_bf16 v33, v57, v25
    v_dot2c_f32_bf16 v32, v46, v26
    v_dot2c_f32_bf16 v33, v58, v26
    v_dot2c_f32_bf16 v32, v47, v27
    v_dot2c_f32_bf16 v33, v59, v27
    v_dot2c_f32_bf16 v32, v48, v28
    v_dot2c_f32_bf16 v33, v60, v28
    v_dot2c_f32_bf16 v32, v49, v29
    v_dot2c_f32_bf16 v33, v61, v29
    v_dot2c_f32_bf16 v32, v50, v30
    v_dot2c_f32_bf16 v33, v62, v30
    v_dot2c_f32_bf16 v32, v51, v31
    v_dot2c_f32_bf16 v33, v63, v31
    s_nop 1
    v_add_f32_dpp v32, v32, v32 quad_perm:[1,0,3,2] row_mask:0xf bank_mask:0xf
    v_add_f32_dpp v33, v33, v33 quad_perm:[1,0,3,2] row_mask:0xf bank_mask:0xf
    s_nop 0
    v_add_f32_dpp v32, v32, v32 quad_perm:[2,3,0,1] row_mask:0xf bank_mask:0xf
    v_add_f32_dpp v33, v33, v33 quad_perm:[2,3,0,1] row_mask:0xf bank_mask:0xf
    s_nop 0
    v_add_f32_dpp v32, v32, v32 row_half_mirror row_mask:0xf bank_mask:0xf
    v_add_f32_dpp v33, v33, v33 row_half_mirror row_mask:0xf bank_mask:0xf
    v_cvt_pk_bf16_f32 v15, v32, v33
    v_lshlrev_b32 v32, 16, v15
    v_and_b32 v33, 0xffff0000, v15
    v_mul_f32 v32, 0x3d93cd3a, v32
    v_mul_f32 v33, 0x3d93cd3a, v33
    v_cvt_pk_bf16_f32 v15, v32, v33
    v_lshlrev_b32 v32, 16, v15
    v_and_b32 v33, 0xffff0000, v15
    s_waitcnt vmcnt(3)
    buffer_load_dwordx4 v[208:211], v1, s[12:15], s83 offen offset:0 nt
    v_mov_b32 v34, 0
    v_mov_b32 v35, 0
    v_dot2c_f32_bf16 v34, v64, v20
    v_dot2c_f32_bf16 v35, v76, v20
    v_dot2c_f32_bf16 v34, v65, v21
    v_dot2c_f32_bf16 v35, v77, v21
    v_dot2c_f32_bf16 v34, v66, v22
    v_dot2c_f32_bf16 v35, v78, v22
    v_dot2c_f32_bf16 v34, v67, v23
    v_dot2c_f32_bf16 v35, v79, v23
    v_dot2c_f32_bf16 v34, v68, v24
    v_dot2c_f32_bf16 v35, v80, v24
    v_dot2c_f32_bf16 v34, v69, v25
    v_dot2c_f32_bf16 v35, v81, v25
    v_dot2c_f32_bf16 v34, v70, v26
    v_dot2c_f32_bf16 v35, v82, v26
    v_dot2c_f32_bf16 v34, v71, v27
    v_dot2c_f32_bf16 v35, v83, v27
    v_dot2c_f32_bf16 v34, v72, v28
    v_dot2c_f32_bf16 v35, v84, v28
    v_dot2c_f32_bf16 v34, v73, v29
    v_dot2c_f32_bf16 v35, v85, v29
    v_dot2c_f32_bf16 v34, v74, v30
    v_dot2c_f32_bf16 v35, v86, v30
    v_dot2c_f32_bf16 v34, v75, v31
    v_dot2c_f32_bf16 v35, v87, v31
    s_nop 1
    v_add_f32_dpp v34, v34, v34 quad_perm:[1,0,3,2] row_mask:0xf bank_mask:0xf
    v_add_f32_dpp v35, v35, v35 quad_perm:[1,0,3,2] row_mask:0xf bank_mask:0xf
    s_nop 0
    v_add_f32_dpp v34, v34, v34 quad_perm:[2,3,0,1] row_mask:0xf bank_mask:0xf
    v_add_f32_dpp v35, v35, v35 quad_perm:[2,3,0,1] row_mask:0xf bank_mask:0xf
    s_nop 0
    v_add_f32_dpp v34, v34, v34 row_half_mirror row_mask:0xf bank_mask:0xf
    v_add_f32_dpp v35, v35, v35 row_half_mirror row_mask:0xf bank_mask:0xf
    v_cvt_pk_bf16_f32 v15, v34, v35
    v_lshlrev_b32 v34, 16, v15
    v_and_b32 v35, 0xffff0000, v15
    v_mul_f32 v34, 0x3d93cd3a, v34
    v_mul_f32 v35, 0x3d93cd3a, v35
    v_cvt_pk_bf16_f32 v15, v34, v35
    v_lshlrev_b32 v34, 16, v15
    v_and_b32 v35, 0xffff0000, v15
    s_waitcnt vmcnt(3)
    buffer_load_dwordx4 v[212:215], v1, s[12:15], s83 offen offset:128 nt
    v_mov_b32 v36, 0
    v_mov_b32 v37, 0
    v_dot2c_f32_bf16 v36, v88, v20
    v_dot2c_f32_bf16 v37, v100, v20
    v_dot2c_f32_bf16 v36, v89, v21
    v_dot2c_f32_bf16 v37, v101, v21
    v_dot2c_f32_bf16 v36, v90, v22
    v_dot2c_f32_bf16 v37, v102, v22
    v_dot2c_f32_bf16 v36, v91, v23
    v_dot2c_f32_bf16 v37, v103, v23
    v_dot2c_f32_bf16 v36, v92, v24
    v_dot2c_f32_bf16 v37, v104, v24
    v_dot2c_f32_bf16 v36, v93, v25
    v_dot2c_f32_bf16 v37, v105, v25
    v_dot2c_f32_bf16 v36, v94, v26
    v_dot2c_f32_bf16 v37, v106, v26
    v_dot2c_f32_bf16 v36, v95, v27
    v_dot2c_f32_bf16 v37, v107, v27
    v_dot2c_f32_bf16 v36, v96, v28
    v_dot2c_f32_bf16 v37, v108, v28
    v_dot2c_f32_bf16 v36, v97, v29
    v_dot2c_f32_bf16 v37, v109, v29
    v_dot2c_f32_bf16 v36, v98, v30
    v_dot2c_f32_bf16 v37, v110, v30
    v_dot2c_f32_bf16 v36, v99, v31
    v_dot2c_f32_bf16 v37, v111, v31
    s_nop 1
    v_add_f32_dpp v36, v36, v36 quad_perm:[1,0,3,2] row_mask:0xf bank_mask:0xf
    v_add_f32_dpp v37, v37, v37 quad_perm:[1,0,3,2] row_mask:0xf bank_mask:0xf
    s_nop 0
    v_add_f32_dpp v36, v36, v36 quad_perm:[2,3,0,1] row_mask:0xf bank_mask:0xf
    v_add_f32_dpp v37, v37, v37 quad_perm:[2,3,0,1] row_mask:0xf bank_mask:0xf
    s_nop 0
    v_add_f32_dpp v36, v36, v36 row_half_mirror row_mask:0xf bank_mask:0xf
    v_add_f32_dpp v37, v37, v37 row_half_mirror row_mask:0xf bank_mask:0xf
    v_cvt_pk_bf16_f32 v15, v36, v37
    v_lshlrev_b32 v36, 16, v15
    v_and_b32 v37, 0xffff0000, v15
    v_mul_f32 v36, 0x3d93cd3a, v36
    v_mul_f32 v37, 0x3d93cd3a, v37
    v_cvt_pk_bf16_f32 v15, v36, v37
    v_lshlrev_b32 v36, 16, v15
    v_and_b32 v37, 0xffff0000, v15
    s_waitcnt vmcnt(3)
    buffer_load_dwordx4 v[216:219], v1, s[12:15], s83 offen offset:256 nt
    v_mov_b32 v38, 0
    v_mov_b32 v39, 0
    v_dot2c_f32_bf16 v38, v112, v20
    v_dot2c_f32_bf16 v39, v124, v20
    v_dot2c_f32_bf16 v38, v113, v21
    v_dot2c_f32_bf16 v39, v125, v21
    v_dot2c_f32_bf16 v38, v114, v22
    v_dot2c_f32_bf16 v39, v126, v22
    v_dot2c_f32_bf16 v38, v115, v23
    v_dot2c_f32_bf16 v39, v127, v23
    v_dot2c_f32_bf16 v38, v116, v24
    v_dot2c_f32_bf16 v39, v128, v24
    v_dot2c_f32_bf16 v38, v117, v25
    v_dot2c_f32_bf16 v39, v129, v25
    v_dot2c_f32_bf16 v38, v118, v26
    v_dot2c_f32_bf16 v39, v130, v26
    v_dot2c_f32_bf16 v38, v119, v27
    v_dot2c_f32_bf16 v39, v131, v27
    v_dot2c_f32_bf16 v38, v120, v28
    v_dot2c_f32_bf16 v39, v132, v28
    v_dot2c_f32_bf16 v38, v121, v29
    v_dot2c_f32_bf16 v39, v133, v29
    v_dot2c_f32_bf16 v38, v122, v30
    v_dot2c_f32_bf16 v39, v134, v30
    v_dot2c_f32_bf16 v38, v123, v31
    v_dot2c_f32_bf16 v39, v135, v31
    s_nop 1
    v_add_f32_dpp v38, v38, v38 quad_perm:[1,0,3,2] row_mask:0xf bank_mask:0xf
    v_add_f32_dpp v39, v39, v39 quad_perm:[1,0,3,2] row_mask:0xf bank_mask:0xf
    s_nop 0
    v_add_f32_dpp v38, v38, v38 quad_perm:[2,3,0,1] row_mask:0xf bank_mask:0xf
    v_add_f32_dpp v39, v39, v39 quad_perm:[2,3,0,1] row_mask:0xf bank_mask:0xf
    s_nop 0
    v_add_f32_dpp v38, v38, v38 row_half_mirror row_mask:0xf bank_mask:0xf
    v_add_f32_dpp v39, v39, v39 row_half_mirror row_mask:0xf bank_mask:0xf
    v_cvt_pk_bf16_f32 v15, v38, v39
    v_lshlrev_b32 v38, 16, v15
    v_and_b32 v39, 0xffff0000, v15
    v_mul_f32 v38, 0x3d93cd3a, v38
    v_mul_f32 v39, 0x3d93cd3a, v39
    v_cvt_pk_bf16_f32 v15, v38, v39
    v_lshlrev_b32 v38, 16, v15
    v_and_b32 v39, 0xffff0000, v15
    s_waitcnt vmcnt(3)
    buffer_load_dwordx4 v[220:223], v1, s[12:15], s84 offen offset:0 nt
    v_mov_b32 v19, 0
    v_dot2c_f32_bf16 v19, v136, v20
    v_dot2c_f32_bf16 v19, v137, v21
    v_dot2c_f32_bf16 v19, v138, v22
    v_dot2c_f32_bf16 v19, v139, v23
    v_dot2c_f32_bf16 v19, v140, v24
    v_dot2c_f32_bf16 v19, v141, v25
    v_dot2c_f32_bf16 v19, v142, v26
    v_dot2c_f32_bf16 v19, v143, v27
    v_dot2c_f32_bf16 v19, v144, v28
    v_dot2c_f32_bf16 v19, v145, v29
    v_dot2c_f32_bf16 v19, v146, v30
    v_dot2c_f32_bf16 v19, v147, v31
    s_nop 2
    v_add_f32_dpp v19, v19, v19 quad_perm:[1,0,3,2] row_mask:0xf bank_mask:0xf
    s_nop 1
    v_add_f32_dpp v19, v19, v19 quad_perm:[2,3,0,1] row_mask:0xf bank_mask:0xf
    s_nop 1
    v_add_f32_dpp v19, v19, v19 row_half_mirror row_mask:0xf bank_mask:0xf
    v_cvt_pk_bf16_f32 v15, v19, v19
    v_lshlrev_b32 v19, 16, v15
    v_mul_f32 v19, 0x3d93cd3a, v19
    v_cvt_pk_bf16_f32 v15, v19, v19
    v_lshlrev_b32 v19, 16, v15
    s_waitcnt vmcnt(3)
    buffer_load_dwordx4 v[224:227], v1, s[12:15], s84 offen offset:128 nt
    v_mov_b32 v15, v32
    v_max3_f32 v15, v15, v33, v34
    v_max3_f32 v15, v15, v35, v36
    v_max3_f32 v15, v15, v37, v38
    v_max3_f32 v15, v15, v39, v19
    s_nop 1
    v_max_f32_dpp v15, v15, v15 row_ror:8 row_mask:0xf bank_mask:0xf
    v_mov_b32 v40, 0
    v_mov_b32 v41, 0
    v_mov_b32 v42, 0
    v_mov_b32 v43, 0
    v_mov_b32 v44, 0
    v_mov_b32 v45, 0
    v_mov_b32 v46, 0
    v_mov_b32 v47, 0
    v_mov_b32 v48, 0
    v_mov_b32 v49, 0
    v_mov_b32 v50, 0
    v_mov_b32 v51, 0
    v_mov_b32 v16, v15
    s_nop 1
    v_permlane16_swap_b32 v15, v16
    v_max_f32 v15, v15, v16
    v_mov_b32 v16, v15
    s_nop 1
    v_permlane32_swap_b32 v15, v16
    v_max_f32 v15, v15, v16
    v_mul_f32 v12, 0x3fb8aa3b, v15
    v_and_b32 v17, 1, v2
    v_lshlrev_b32 v17, 4, v17
    v_mov_b32 v18, 0xffff
    v_lshlrev_b32 v18, v17, v18
    v_bfe_u32 v17, v2, 1, 2
    v_cmp_eq_u32 vcc, 0, v17
    s_nop 1
    v_cndmask_b32 v52, 0, v18, vcc
    v_cmp_eq_u32 vcc, 1, v17
    s_nop 1
    v_cndmask_b32 v53, 0, v18, vcc
    v_cmp_eq_u32 vcc, 2, v17
    s_nop 1
    v_cndmask_b32 v54, 0, v18, vcc
    v_cmp_eq_u32 vcc, 3, v17
    s_nop 1
    v_cndmask_b32 v55, 0, v18, vcc
    s_waitcnt vmcnt(3)
    buffer_load_dwordx4 v[228:231], v1, s[12:15], s84 offen offset:256 nt
    s_mov_b32 s62, 0x3fb8aa3b
    v_fma_f32 v32, v32, s62, -v12
    v_fma_f32 v33, v33, s62, -v12
    v_fma_f32 v34, v34, s62, -v12
    v_fma_f32 v35, v35, s62, -v12
    v_fma_f32 v36, v36, s62, -v12
    v_fma_f32 v37, v37, s62, -v12
    v_fma_f32 v38, v38, s62, -v12
    v_fma_f32 v39, v39, s62, -v12
    v_fma_f32 v19, v19, s62, -v12
    v_exp_f32 v32, v32
    v_exp_f32 v33, v33
    v_exp_f32 v34, v34
    v_exp_f32 v35, v35
    v_exp_f32 v36, v36
    v_exp_f32 v37, v37
    v_exp_f32 v38, v38
    v_exp_f32 v39, v39
    v_exp_f32 v19, v19
    v_cvt_pk_bf16_f32 v32, v32, v32
    v_cvt_pk_bf16_f32 v33, v33, v33
    v_cvt_pk_bf16_f32 v34, v34, v34
    v_cvt_pk_bf16_f32 v35, v35, v35
    v_cvt_pk_bf16_f32 v36, v36, v36
    v_cvt_pk_bf16_f32 v37, v37, v37
    v_cvt_pk_bf16_f32 v38, v38, v38
    v_cvt_pk_bf16_f32 v39, v39, v39
    v_cvt_pk_bf16_f32 v19, v19, v19
    s_waitcnt vmcnt(3)
    buffer_load_dwordx4 v[232:235], v1, s[12:15], s85 offen offset:0 nt
    v_and_b32 v56, v52, v32
    v_and_b32 v57, v53, v32
    v_and_b32 v58, v54, v32
    v_and_b32 v59, v55, v32
    v_and_b32 v60, v52, v33
    v_and_b32 v61, v53, v33
    v_and_b32 v62, v54, v33
    v_and_b32 v63, v55, v33
    v_and_b32 v64, v52, v34
    v_and_b32 v65, v53, v34
    v_and_b32 v66, v54, v34
    v_and_b32 v67, v55, v34
    v_and_b32 v68, v52, v35
    v_and_b32 v69, v53, v35
    v_and_b32 v70, v54, v35
    v_and_b32 v71, v55, v35
    v_and_b32 v72, v52, v36
    v_and_b32 v73, v53, v36
    v_and_b32 v74, v54, v36
    v_and_b32 v75, v55, v36
    v_and_b32 v76, v52, v37
    v_and_b32 v77, v53, v37
    v_and_b32 v78, v54, v37
    v_and_b32 v79, v55, v37
    v_and_b32 v80, v52, v38
    v_and_b32 v81, v53, v38
    v_and_b32 v82, v54, v38
    v_and_b32 v83, v55, v38
    v_and_b32 v84, v52, v39
    v_and_b32 v85, v53, v39
    v_and_b32 v86, v54, v39
    v_and_b32 v87, v55, v39
    v_and_b32 v88, v52, v19
    v_and_b32 v89, v53, v19
    v_and_b32 v90, v54, v19
    v_and_b32 v91, v55, v19
    s_waitcnt vmcnt(3)
    buffer_load_dwordx4 v[236:239], v1, s[12:15], s85 offen offset:128 nt
    v_and_b32 v13, 0xffff0000, v32
    v_and_b32 v15, 0xffff0000, v33
    v_add_f32 v13, v13, v15
    v_and_b32 v15, 0xffff0000, v34
    v_add_f32 v13, v13, v15
    v_and_b32 v15, 0xffff0000, v35
    v_add_f32 v13, v13, v15
    v_and_b32 v15, 0xffff0000, v36
    v_add_f32 v13, v13, v15
    v_and_b32 v15, 0xffff0000, v37
    v_add_f32 v13, v13, v15
    v_and_b32 v15, 0xffff0000, v38
    v_add_f32 v13, v13, v15
    v_and_b32 v15, 0xffff0000, v39
    v_add_f32 v13, v13, v15
    v_and_b32 v15, 0xffff0000, v19
    v_add_f32 v13, v13, v15
    s_nop 1
    v_add_f32_dpp v13, v13, v13 row_ror:8 row_mask:0xf bank_mask:0xf
    v_mov_b32 v16, v13
    s_nop 1
    v_permlane16_swap_b32 v13, v16
    v_add_f32 v13, v13, v16
    v_mov_b32 v16, v13
    s_nop 1
    v_permlane32_swap_b32 v13, v16
    v_add_f32 v13, v13, v16
    s_lshl_b32 s62, s3, 3
    v_mov_b32 v16, s62
    ds_write_b64 v16, v[12:13] offset:3584
    s_waitcnt vmcnt(3)
    buffer_load_dwordx4 v[240:243], v1, s[12:15], s85 offen offset:256 nt
    v_mfma_f32_16x16x32_bf16 v[40:43], v[56:59], v[148:151], v[40:43]
    v_mfma_f32_16x16x32_bf16 v[44:47], v[56:59], v[152:155], v[44:47]
    v_mfma_f32_16x16x32_bf16 v[48:51], v[56:59], v[156:159], v[48:51]
    v_mfma_f32_16x16x32_bf16 v[40:43], v[60:63], v[160:163], v[40:43]
    v_mfma_f32_16x16x32_bf16 v[44:47], v[60:63], v[164:167], v[44:47]
    v_mfma_f32_16x16x32_bf16 v[48:51], v[60:63], v[168:171], v[48:51]
    v_mfma_f32_16x16x32_bf16 v[40:43], v[64:67], v[172:175], v[40:43]
    v_mfma_f32_16x16x32_bf16 v[44:47], v[64:67], v[176:179], v[44:47]
    s_waitcnt vmcnt(3)
    buffer_load_dwordx4 v[244:247], v1, s[12:15], s86 offen offset:0 nt
    v_mfma_f32_16x16x32_bf16 v[48:51], v[64:67], v[180:183], v[48:51]
    v_mfma_f32_16x16x32_bf16 v[40:43], v[68:71], v[184:187], v[40:43]
    v_mfma_f32_16x16x32_bf16 v[44:47], v[68:71], v[188:191], v[44:47]
    v_mfma_f32_16x16x32_bf16 v[48:51], v[68:71], v[192:195], v[48:51]
    v_mfma_f32_16x16x32_bf16 v[40:43], v[72:75], v[196:199], v[40:43]
    v_mfma_f32_16x16x32_bf16 v[44:47], v[72:75], v[200:203], v[44:47]
    v_mfma_f32_16x16x32_bf16 v[48:51], v[72:75], v[204:207], v[48:51]
    v_mfma_f32_16x16x32_bf16 v[40:43], v[76:79], v[208:211], v[40:43]
    s_waitcnt vmcnt(3)
    buffer_load_dwordx4 v[248:251], v1, s[12:15], s86 offen offset:128 nt
    v_mfma_f32_16x16x32_bf16 v[44:47], v[76:79], v[212:215], v[44:47]
    v_mfma_f32_16x16x32_bf16 v[48:51], v[76:79], v[216:219], v[48:51]
    v_mfma_f32_16x16x32_bf16 v[40:43], v[80:83], v[220:223], v[40:43]
    v_mfma_f32_16x16x32_bf16 v[44:47], v[80:83], v[224:227], v[44:47]
    v_mfma_f32_16x16x32_bf16 v[48:51], v[80:83], v[228:231], v[48:51]
    v_mfma_f32_16x16x32_bf16 v[40:43], v[84:87], v[232:235], v[40:43]
    s_waitcnt vmcnt(3)
    buffer_load_dwordx4 v[252:255], v1, s[12:15], s86 offen offset:256 nt
    v_mfma_f32_16x16x32_bf16 v[44:47], v[84:87], v[236:239], v[44:47]
    s_waitcnt vmcnt(3)
    buffer_load_dwordx4 v[116:119], v5, s[36:39], s53 offen offset:0 nt
    v_mfma_f32_16x16x32_bf16 v[48:51], v[84:87], v[240:243], v[48:51]
    s_waitcnt vmcnt(3)
    buffer_load_dwordx4 v[120:123], v5, s[36:39], s53 offen offset:1280 nt
    v_mfma_f32_16x16x32_bf16 v[40:43], v[88:91], v[244:247], v[40:43]
    s_waitcnt vmcnt(3)
    buffer_load_dwordx4 v[92:95], v4, s[24:27], s52 offen offset:0 nt
    v_mfma_f32_16x16x32_bf16 v[44:47], v[88:91], v[248:251], v[44:47]
    buffer_load_dwordx4 v[96:99], v4, s[24:27], s52 offen offset:1280 nt
    buffer_load_dwordx4 v[100:103], v4, s[24:27], s52 offen offset:2560 nt
    buffer_load_dwordx4 v[104:107], v4, s[24:27], s52 offen offset:3840 nt
    buffer_load_dwordx4 v[108:111], v4, s[24:27], s64 offen offset:0 nt
    buffer_load_dwordx4 v[112:115], v4, s[24:27], s64 offen offset:1280 nt
    s_waitcnt vmcnt(8)
    v_mfma_f32_16x16x32_bf16 v[48:51], v[88:91], v[252:255], v[48:51]
    s_nop 7
    s_branch L_tail
L_cont17:
    ds_read_b128 v[20:23], v3 offset:2816
    ds_read_b128 v[24:27], v3 offset:2944
    ds_read_b128 v[28:31], v3 offset:3072
    ds_read_b32 v10, v9 offset:3200
    s_waitcnt vmcnt(3)
    buffer_load_dwordx4 v[216:219], v1, s[12:15], s83 offen offset:256 nt
    s_waitcnt lgkmcnt(0)
    v_mov_b32 v32, 0
    v_mov_b32 v33, 0
    v_dot2c_f32_bf16 v32, v40, v20
    v_dot2c_f32_bf16 v33, v52, v20
    v_dot2c_f32_bf16 v32, v41, v21
    v_dot2c_f32_bf16 v33, v53, v21
    v_dot2c_f32_bf16 v32, v42, v22
    v_dot2c_f32_bf16 v33, v54, v22
    v_dot2c_f32_bf16 v32, v43, v23
    v_dot2c_f32_bf16 v33, v55, v23
    v_dot2c_f32_bf16 v32, v44, v24
    v_dot2c_f32_bf16 v33, v56, v24
    v_dot2c_f32_bf16 v32, v45, v25
    v_dot2c_f32_bf16 v33, v57, v25
    v_dot2c_f32_bf16 v32, v46, v26
    v_dot2c_f32_bf16 v33, v58, v26
    v_dot2c_f32_bf16 v32, v47, v27
    v_dot2c_f32_bf16 v33, v59, v27
    v_dot2c_f32_bf16 v32, v48, v28
    v_dot2c_f32_bf16 v33, v60, v28
    v_dot2c_f32_bf16 v32, v49, v29
    v_dot2c_f32_bf16 v33, v61, v29
    v_dot2c_f32_bf16 v32, v50, v30
    v_dot2c_f32_bf16 v33, v62, v30
    v_dot2c_f32_bf16 v32, v51, v31
    v_dot2c_f32_bf16 v33, v63, v31
    s_nop 1
    v_add_f32_dpp v32, v32, v32 quad_perm:[1,0,3,2] row_mask:0xf bank_mask:0xf
    v_add_f32_dpp v33, v33, v33 quad_perm:[1,0,3,2] row_mask:0xf bank_mask:0xf
    s_nop 0
    v_add_f32_dpp v32, v32, v32 quad_perm:[2,3,0,1] row_mask:0xf bank_mask:0xf
    v_add_f32_dpp v33, v33, v33 quad_perm:[2,3,0,1] row_mask:0xf bank_mask:0xf
    s_nop 0
    v_add_f32_dpp v32, v32, v32 row_half_mirror row_mask:0xf bank_mask:0xf
    v_add_f32_dpp v33, v33, v33 row_half_mirror row_mask:0xf bank_mask:0xf
    v_cvt_pk_bf16_f32 v15, v32, v33
    v_lshlrev_b32 v32, 16, v15
    v_and_b32 v33, 0xffff0000, v15
    v_mul_f32 v32, 0x3d93cd3a, v32
    v_mul_f32 v33, 0x3d93cd3a, v33
    v_cvt_pk_bf16_f32 v15, v32, v33
    v_lshlrev_b32 v32, 16, v15
    v_and_b32 v33, 0xffff0000, v15
    v_mov_b32 v34, 0
    v_mov_b32 v35, 0
    v_dot2c_f32_bf16 v34, v64, v20
    v_dot2c_f32_bf16 v35, v76, v20
    v_dot2c_f32_bf16 v34, v65, v21
    v_dot2c_f32_bf16 v35, v77, v21
    v_dot2c_f32_bf16 v34, v66, v22
    v_dot2c_f32_bf16 v35, v78, v22
    v_dot2c_f32_bf16 v34, v67, v23
    v_dot2c_f32_bf16 v35, v79, v23
    v_dot2c_f32_bf16 v34, v68, v24
    v_dot2c_f32_bf16 v35, v80, v24
    v_dot2c_f32_bf16 v34, v69, v25
    v_dot2c_f32_bf16 v35, v81, v25
    v_dot2c_f32_bf16 v34, v70, v26
    v_dot2c_f32_bf16 v35, v82, v26
    v_dot2c_f32_bf16 v34, v71, v27
    v_dot2c_f32_bf16 v35, v83, v27
    v_dot2c_f32_bf16 v34, v72, v28
    v_dot2c_f32_bf16 v35, v84, v28
    v_dot2c_f32_bf16 v34, v73, v29
    v_dot2c_f32_bf16 v35, v85, v29
    v_dot2c_f32_bf16 v34, v74, v30
    v_dot2c_f32_bf16 v35, v86, v30
    v_dot2c_f32_bf16 v34, v75, v31
    v_dot2c_f32_bf16 v35, v87, v31
    s_nop 1
    v_add_f32_dpp v34, v34, v34 quad_perm:[1,0,3,2] row_mask:0xf bank_mask:0xf
    v_add_f32_dpp v35, v35, v35 quad_perm:[1,0,3,2] row_mask:0xf bank_mask:0xf
    s_nop 0
    v_add_f32_dpp v34, v34, v34 quad_perm:[2,3,0,1] row_mask:0xf bank_mask:0xf
    v_add_f32_dpp v35, v35, v35 quad_perm:[2,3,0,1] row_mask:0xf bank_mask:0xf
    s_nop 0
    v_add_f32_dpp v34, v34, v34 row_half_mirror row_mask:0xf bank_mask:0xf
    v_add_f32_dpp v35, v35, v35 row_half_mirror row_mask:0xf bank_mask:0xf
    v_cvt_pk_bf16_f32 v15, v34, v35
    v_lshlrev_b32 v34, 16, v15
    v_and_b32 v35, 0xffff0000, v15
    v_mul_f32 v34, 0x3d93cd3a, v34
    v_mul_f32 v35, 0x3d93cd3a, v35
    v_cvt_pk_bf16_f32 v15, v34, v35
    v_lshlrev_b32 v34, 16, v15
    v_and_b32 v35, 0xffff0000, v15
    s_waitcnt vmcnt(3)
    buffer_load_dwordx4 v[220:223], v1, s[12:15], s84 offen offset:0 nt
    v_mov_b32 v36, 0
    v_mov_b32 v37, 0
    v_dot2c_f32_bf16 v36, v88, v20
    v_dot2c_f32_bf16 v37, v100, v20
    v_dot2c_f32_bf16 v36, v89, v21
    v_dot2c_f32_bf16 v37, v101, v21
    v_dot2c_f32_bf16 v36, v90, v22
    v_dot2c_f32_bf16 v37, v102, v22
    v_dot2c_f32_bf16 v36, v91, v23
    v_dot2c_f32_bf16 v37, v103, v23
    v_dot2c_f32_bf16 v36, v92, v24
    v_dot2c_f32_bf16 v37, v104, v24
    v_dot2c_f32_bf16 v36, v93, v25
    v_dot2c_f32_bf16 v37, v105, v25
    v_dot2c_f32_bf16 v36, v94, v26
    v_dot2c_f32_bf16 v37, v106, v26
    v_dot2c_f32_bf16 v36, v95, v27
    v_dot2c_f32_bf16 v37, v107, v27
    v_dot2c_f32_bf16 v36, v96, v28
    v_dot2c_f32_bf16 v37, v108, v28
    v_dot2c_f32_bf16 v36, v97, v29
    v_dot2c_f32_bf16 v37, v109, v29
    v_dot2c_f32_bf16 v36, v98, v30
    v_dot2c_f32_bf16 v37, v110, v30
    v_dot2c_f32_bf16 v36, v99, v31
    v_dot2c_f32_bf16 v37, v111, v31
    s_nop 1
    v_add_f32_dpp v36, v36, v36 quad_perm:[1,0,3,2] row_mask:0xf bank_mask:0xf
    v_add_f32_dpp v37, v37, v37 quad_perm:[1,0,3,2] row_mask:0xf bank_mask:0xf
    s_nop 0
    v_add_f32_dpp v36, v36, v36 quad_perm:[2,3,0,1] row_mask:0xf bank_mask:0xf
    v_add_f32_dpp v37, v37, v37 quad_perm:[2,3,0,1] row_mask:0xf bank_mask:0xf
    s_nop 0
    v_add_f32_dpp v36, v36, v36 row_half_mirror row_mask:0xf bank_mask:0xf
    v_add_f32_dpp v37, v37, v37 row_half_mirror row_mask:0xf bank_mask:0xf
    v_cvt_pk_bf16_f32 v15, v36, v37
    v_lshlrev_b32 v36, 16, v15
    v_and_b32 v37, 0xffff0000, v15
    v_mul_f32 v36, 0x3d93cd3a, v36
    v_mul_f32 v37, 0x3d93cd3a, v37
    v_cvt_pk_bf16_f32 v15, v36, v37
    v_lshlrev_b32 v36, 16, v15
    v_and_b32 v37, 0xffff0000, v15
    v_mov_b32 v38, 0
    v_mov_b32 v39, 0
    v_dot2c_f32_bf16 v38, v112, v20
    v_dot2c_f32_bf16 v39, v124, v20
    v_dot2c_f32_bf16 v38, v113, v21
    v_dot2c_f32_bf16 v39, v125, v21
    v_dot2c_f32_bf16 v38, v114, v22
    v_dot2c_f32_bf16 v39, v126, v22
    v_dot2c_f32_bf16 v38, v115, v23
    v_dot2c_f32_bf16 v39, v127, v23
    v_dot2c_f32_bf16 v38, v116, v24
    v_dot2c_f32_bf16 v39, v128, v24
    v_dot2c_f32_bf16 v38, v117, v25
    v_dot2c_f32_bf16 v39, v129, v25
    v_dot2c_f32_bf16 v38, v118, v26
    v_dot2c_f32_bf16 v39, v130, v26
    v_dot2c_f32_bf16 v38, v119, v27
    v_dot2c_f32_bf16 v39, v131, v27
    v_dot2c_f32_bf16 v38, v120, v28
    v_dot2c_f32_bf16 v39, v132, v28
    v_dot2c_f32_bf16 v38, v121, v29
    v_dot2c_f32_bf16 v39, v133, v29
    v_dot2c_f32_bf16 v38, v122, v30
    v_dot2c_f32_bf16 v39, v134, v30
    v_dot2c_f32_bf16 v38, v123, v31
    v_dot2c_f32_bf16 v39, v135, v31
    s_nop 1
    v_add_f32_dpp v38, v38, v38 quad_perm:[1,0,3,2] row_mask:0xf bank_mask:0xf
    v_add_f32_dpp v39, v39, v39 quad_perm:[1,0,3,2] row_mask:0xf bank_mask:0xf
    s_nop 0
    v_add_f32_dpp v38, v38, v38 quad_perm:[2,3,0,1] row_mask:0xf bank_mask:0xf
    v_add_f32_dpp v39, v39, v39 quad_perm:[2,3,0,1] row_mask:0xf bank_mask:0xf
    s_nop 0
    v_add_f32_dpp v38, v38, v38 row_half_mirror row_mask:0xf bank_mask:0xf
    v_add_f32_dpp v39, v39, v39 row_half_mirror row_mask:0xf bank_mask:0xf
    v_cvt_pk_bf16_f32 v15, v38, v39
    v_lshlrev_b32 v38, 16, v15
    v_and_b32 v39, 0xffff0000, v15
    v_mul_f32 v38, 0x3d93cd3a, v38
    v_mul_f32 v39, 0x3d93cd3a, v39
    v_cvt_pk_bf16_f32 v15, v38, v39
    v_lshlrev_b32 v38, 16, v15
    v_and_b32 v39, 0xffff0000, v15
    s_waitcnt vmcnt(3)
    buffer_load_dwordx4 v[224:227], v1, s[12:15], s84 offen offset:128 nt
    v_mov_b32 v19, 0
    v_dot2c_f32_bf16 v19, v136, v20
    v_dot2c_f32_bf16 v19, v137, v21
    v_dot2c_f32_bf16 v19, v138, v22
    v_dot2c_f32_bf16 v19, v139, v23
    v_dot2c_f32_bf16 v19, v140, v24
    v_dot2c_f32_bf16 v19, v141, v25
    v_dot2c_f32_bf16 v19, v142, v26
    v_dot2c_f32_bf16 v19, v143, v27
    v_dot2c_f32_bf16 v19, v144, v28
    v_dot2c_f32_bf16 v19, v145, v29
    v_dot2c_f32_bf16 v19, v146, v30
    v_dot2c_f32_bf16 v19, v147, v31
    s_nop 2
    v_add_f32_dpp v19, v19, v19 quad_perm:[1,0,3,2] row_mask:0xf bank_mask:0xf
    s_nop 1
    v_add_f32_dpp v19, v19, v19 quad_perm:[2,3,0,1] row_mask:0xf bank_mask:0xf
    s_nop 1
    v_add_f32_dpp v19, v19, v19 row_half_mirror row_mask:0xf bank_mask:0xf
    v_cvt_pk_bf16_f32 v15, v19, v19
    v_lshlrev_b32 v19, 16, v15
    v_mul_f32 v19, 0x3d93cd3a, v19
    v_cvt_pk_bf16_f32 v15, v19, v19
    v_lshlrev_b32 v19, 16, v15
    v_mov_b32 v15, v32
    v_max3_f32 v15, v15, v33, v34
    v_max3_f32 v15, v15, v35, v36
    v_max3_f32 v15, v15, v37, v38
    v_max3_f32 v15, v15, v39, v19
    s_nop 1
    v_max_f32_dpp v15, v15, v15 row_ror:8 row_mask:0xf bank_mask:0xf
    v_mov_b32 v40, 0
    v_mov_b32 v41, 0
    v_mov_b32 v42, 0
    v_mov_b32 v43, 0
    v_mov_b32 v44, 0
    v_mov_b32 v45, 0
    v_mov_b32 v46, 0
    v_mov_b32 v47, 0
    v_mov_b32 v48, 0
    v_mov_b32 v49, 0
    v_mov_b32 v50, 0
    v_mov_b32 v51, 0
    v_mov_b32 v16, v15
    s_nop 1
    v_permlane16_swap_b32 v15, v16
    v_max_f32 v15, v15, v16
    v_mov_b32 v16, v15
    s_nop 1
    v_permlane32_swap_b32 v15, v16
    v_max_f32 v15, v15, v16
    v_mul_f32 v12, 0x3fb8aa3b, v15
    v_and_b32 v17, 1, v2
    v_lshlrev_b32 v17, 4, v17
    v_mov_b32 v18, 0xffff
    v_lshlrev_b32 v18, v17, v18
    v_bfe_u32 v17, v2, 1, 2
    v_cmp_eq_u32 vcc, 0, v17
    s_nop 1
    v_cndmask_b32 v52, 0, v18, vcc
    v_cmp_eq_u32 vcc, 1, v17
    s_nop 1
    v_cndmask_b32 v53, 0, v18, vcc
    v_cmp_eq_u32 vcc, 2, v17
    s_nop 1
    v_cndmask_b32 v54, 0, v18, vcc
    v_cmp_eq_u32 vcc, 3, v17
    s_nop 1
    v_cndmask_b32 v55, 0, v18, vcc
    s_waitcnt vmcnt(3)
    buffer_load_dwordx4 v[228:231], v1, s[12:15], s84 offen offset:256 nt
    s_mov_b32 s62, 0x3fb8aa3b
    v_fma_f32 v32, v32, s62, -v12
    v_fma_f32 v33, v33, s62, -v12
    v_fma_f32 v34, v34, s62, -v12
    v_fma_f32 v35, v35, s62, -v12
    v_fma_f32 v36, v36, s62, -v12
    v_fma_f32 v37, v37, s62, -v12
    v_fma_f32 v38, v38, s62, -v12
    v_fma_f32 v39, v39, s62, -v12
    v_fma_f32 v19, v19, s62, -v12
    v_exp_f32 v32, v32
    v_exp_f32 v33, v33
    v_exp_f32 v34, v34
    v_exp_f32 v35, v35
    v_exp_f32 v36, v36
    v_exp_f32 v37, v37
    v_exp_f32 v38, v38
    v_exp_f32 v39, v39
    v_exp_f32 v19, v19
    v_cvt_pk_bf16_f32 v32, v32, v32
    v_cvt_pk_bf16_f32 v33, v33, v33
    v_cvt_pk_bf16_f32 v34, v34, v34
    v_cvt_pk_bf16_f32 v35, v35, v35
    v_cvt_pk_bf16_f32 v36, v36, v36
    v_cvt_pk_bf16_f32 v37, v37, v37
    v_cvt_pk_bf16_f32 v38, v38, v38
    v_cvt_pk_bf16_f32 v39, v39, v39
    v_cvt_pk_bf16_f32 v19, v19, v19
    v_and_b32 v56, v52, v32
    v_and_b32 v57, v53, v32
    v_and_b32 v58, v54, v32
    v_and_b32 v59, v55, v32
    v_and_b32 v60, v52, v33
    v_and_b32 v61, v53, v33
    v_and_b32 v62, v54, v33
    v_and_b32 v63, v55, v33
    v_and_b32 v64, v52, v34
    v_and_b32 v65, v53, v34
    v_and_b32 v66, v54, v34
    v_and_b32 v67, v55, v34
    v_and_b32 v68, v52, v35
    v_and_b32 v69, v53, v35
    v_and_b32 v70, v54, v35
    v_and_b32 v71, v55, v35
    v_and_b32 v72, v52, v36
    v_and_b32 v73, v53, v36
    v_and_b32 v74, v54, v36
    v_and_b32 v75, v55, v36
    v_and_b32 v76, v52, v37
    v_and_b32 v77, v53, v37
    v_and_b32 v78, v54, v37
    v_and_b32 v79, v55, v37
    v_and_b32 v80, v52, v38
    v_and_b32 v81, v53, v38
    v_and_b32 v82, v54, v38
    v_and_b32 v83, v55, v38
    v_and_b32 v84, v52, v39
    v_and_b32 v85, v53, v39
    v_and_b32 v86, v54, v39
    v_and_b32 v87, v55, v39
    v_and_b32 v88, v52, v19
    v_and_b32 v89, v53, v19
    v_and_b32 v90, v54, v19
    v_and_b32 v91, v55, v19
    s_waitcnt vmcnt(3)
    buffer_load_dwordx4 v[232:235], v1, s[12:15], s85 offen offset:0 nt
    v_and_b32 v13, 0xffff0000, v32
    v_and_b32 v15, 0xffff0000, v33
    v_add_f32 v13, v13, v15
    v_and_b32 v15, 0xffff0000, v34
    v_add_f32 v13, v13, v15
    v_and_b32 v15, 0xffff0000, v35
    v_add_f32 v13, v13, v15
    v_and_b32 v15, 0xffff0000, v36
    v_add_f32 v13, v13, v15
    v_and_b32 v15, 0xffff0000, v37
    v_add_f32 v13, v13, v15
    v_and_b32 v15, 0xffff0000, v38
    v_add_f32 v13, v13, v15
    v_and_b32 v15, 0xffff0000, v39
    v_add_f32 v13, v13, v15
    v_and_b32 v15, 0xffff0000, v19
    v_add_f32 v13, v13, v15
    s_nop 1
    v_add_f32_dpp v13, v13, v13 row_ror:8 row_mask:0xf bank_mask:0xf
    v_mov_b32 v16, v13
    s_nop 1
    v_permlane16_swap_b32 v13, v16
    v_add_f32 v13, v13, v16
    v_mov_b32 v16, v13
    s_nop 1
    v_permlane32_swap_b32 v13, v16
    v_add_f32 v13, v13, v16
    s_lshl_b32 s62, s3, 3
    v_mov_b32 v16, s62
    ds_write_b64 v16, v[12:13] offset:3584
    v_mfma_f32_16x16x32_bf16 v[40:43], v[56:59], v[148:151], v[40:43]
    v_mfma_f32_16x16x32_bf16 v[44:47], v[56:59], v[152:155], v[44:47]
    v_mfma_f32_16x16x32_bf16 v[48:51], v[56:59], v[156:159], v[48:51]
    v_mfma_f32_16x16x32_bf16 v[40:43], v[60:63], v[160:163], v[40:43]
    v_mfma_f32_16x16x32_bf16 v[44:47], v[60:63], v[164:167], v[44:47]
    v_mfma_f32_16x16x32_bf16 v[48:51], v[60:63], v[168:171], v[48:51]
    v_mfma_f32_16x16x32_bf16 v[40:43], v[64:67], v[172:175], v[40:43]
    v_mfma_f32_16x16x32_bf16 v[44:47], v[64:67], v[176:179], v[44:47]
    s_waitcnt vmcnt(3)
    buffer_load_dwordx4 v[236:239], v1, s[12:15], s85 offen offset:128 nt
    v_mfma_f32_16x16x32_bf16 v[48:51], v[64:67], v[180:183], v[48:51]
    v_mfma_f32_16x16x32_bf16 v[40:43], v[68:71], v[184:187], v[40:43]
    v_mfma_f32_16x16x32_bf16 v[44:47], v[68:71], v[188:191], v[44:47]
    v_mfma_f32_16x16x32_bf16 v[48:51], v[68:71], v[192:195], v[48:51]
    v_mfma_f32_16x16x32_bf16 v[40:43], v[72:75], v[196:199], v[40:43]
    v_mfma_f32_16x16x32_bf16 v[44:47], v[72:75], v[200:203], v[44:47]
    v_mfma_f32_16x16x32_bf16 v[48:51], v[72:75], v[204:207], v[48:51]
    v_mfma_f32_16x16x32_bf16 v[40:43], v[76:79], v[208:211], v[40:43]
    v_mfma_f32_16x16x32_bf16 v[44:47], v[76:79], v[212:215], v[44:47]
    v_mfma_f32_16x16x32_bf16 v[48:51], v[76:79], v[216:219], v[48:51]
    v_mfma_f32_16x16x32_bf16 v[40:43], v[80:83], v[220:223], v[40:43]
    s_waitcnt vmcnt(3)
    buffer_load_dwordx4 v[240:243], v1, s[12:15], s85 offen offset:256 nt
    v_mfma_f32_16x16x32_bf16 v[44:47], v[80:83], v[224:227], v[44:47]
    s_waitcnt vmcnt(3)
    buffer_load_dwordx4 v[244:247], v1, s[12:15], s86 offen offset:0 nt
    v_mfma_f32_16x16x32_bf16 v[48:51], v[80:83], v[228:231], v[48:51]
    s_waitcnt vmcnt(3)
    buffer_load_dwordx4 v[248:251], v1, s[12:15], s86 offen offset:128 nt
    v_mfma_f32_16x16x32_bf16 v[40:43], v[84:87], v[232:235], v[40:43]
    s_waitcnt vmcnt(3)
    buffer_load_dwordx4 v[252:255], v1, s[12:15], s86 offen offset:256 nt
    v_mfma_f32_16x16x32_bf16 v[44:47], v[84:87], v[236:239], v[44:47]
    s_waitcnt vmcnt(3)
    buffer_load_dwordx4 v[116:119], v5, s[36:39], s53 offen offset:0 nt
    v_mfma_f32_16x16x32_bf16 v[48:51], v[84:87], v[240:243], v[48:51]
    s_waitcnt vmcnt(3)
    buffer_load_dwordx4 v[120:123], v5, s[36:39], s53 offen offset:1280 nt
    v_mfma_f32_16x16x32_bf16 v[40:43], v[88:91], v[244:247], v[40:43]
    s_waitcnt vmcnt(3)
    buffer_load_dwordx4 v[92:95], v4, s[24:27], s52 offen offset:0 nt
    v_mfma_f32_16x16x32_bf16 v[44:47], v[88:91], v[248:251], v[44:47]
    buffer_load_dwordx4 v[96:99], v4, s[24:27], s52 offen offset:1280 nt
    buffer_load_dwordx4 v[100:103], v4, s[24:27], s52 offen offset:2560 nt
    buffer_load_dwordx4 v[104:107], v4, s[24:27], s52 offen offset:3840 nt
    buffer_load_dwordx4 v[108:111], v4, s[24:27], s64 offen offset:0 nt
    buffer_load_dwordx4 v[112:115], v4, s[24:27], s64 offen offset:1280 nt
    s_waitcnt vmcnt(8)
    v_mfma_f32_16x16x32_bf16 v[48:51], v[88:91], v[252:255], v[48:51]
    s_nop 7
    s_branch L_tail
L_cont20:
    ds_read_b128 v[20:23], v3 offset:2816
    ds_read_b128 v[24:27], v3 offset:2944
    ds_read_b128 v[28:31], v3 offset:3072
    ds_read_b32 v10, v9 offset:3200
    s_waitcnt vmcnt(3)
    buffer_load_dwordx4 v[228:231], v1, s[12:15], s84 offen offset:256 nt
    s_waitcnt lgkmcnt(0)
    v_mov_b32 v32, 0
    v_mov_b32 v33, 0
    v_dot2c_f32_bf16 v32, v40, v20
    v_dot2c_f32_bf16 v33, v52, v20
    v_dot2c_f32_bf16 v32, v41, v21
    v_dot2c_f32_bf16 v33, v53, v21
    v_dot2c_f32_bf16 v32, v42, v22
    v_dot2c_f32_bf16 v33, v54, v22
    v_dot2c_f32_bf16 v32, v43, v23
    v_dot2c_f32_bf16 v33, v55, v23
    v_dot2c_f32_bf16 v32, v44, v24
    v_dot2c_f32_bf16 v33, v56, v24
    v_dot2c_f32_bf16 v32, v45, v25
    v_dot2c_f32_bf16 v33, v57, v25
    v_dot2c_f32_bf16 v32, v46, v26
    v_dot2c_f32_bf16 v33, v58, v26
    v_dot2c_f32_bf16 v32, v47, v27
    v_dot2c_f32_bf16 v33, v59, v27
    v_dot2c_f32_bf16 v32, v48, v28
    v_dot2c_f32_bf16 v33, v60, v28
    v_dot2c_f32_bf16 v32, v49, v29
    v_dot2c_f32_bf16 v33, v61, v29
    v_dot2c_f32_bf16 v32, v50, v30
    v_dot2c_f32_bf16 v33, v62, v30
    v_dot2c_f32_bf16 v32, v51, v31
    v_dot2c_f32_bf16 v33, v63, v31
    s_nop 1
    v_add_f32_dpp v32, v32, v32 quad_perm:[1,0,3,2] row_mask:0xf bank_mask:0xf
    v_add_f32_dpp v33, v33, v33 quad_perm:[1,0,3,2] row_mask:0xf bank_mask:0xf
    s_nop 0
    v_add_f32_dpp v32, v32, v32 quad_perm:[2,3,0,1] row_mask:0xf bank_mask:0xf
    v_add_f32_dpp v33, v33, v33 quad_perm:[2,3,0,1] row_mask:0xf bank_mask:0xf
    s_nop 0
    v_add_f32_dpp v32, v32, v32 row_half_mirror row_mask:0xf bank_mask:0xf
    v_add_f32_dpp v33, v33, v33 row_half_mirror row_mask:0xf bank_mask:0xf
    v_cvt_pk_bf16_f32 v15, v32, v33
    v_lshlrev_b32 v32, 16, v15
    v_and_b32 v33, 0xffff0000, v15
    v_mul_f32 v32, 0x3d93cd3a, v32
    v_mul_f32 v33, 0x3d93cd3a, v33
    v_cvt_pk_bf16_f32 v15, v32, v33
    v_lshlrev_b32 v32, 16, v15
    v_and_b32 v33, 0xffff0000, v15
    v_mov_b32 v34, 0
    v_mov_b32 v35, 0
    v_dot2c_f32_bf16 v34, v64, v20
    v_dot2c_f32_bf16 v35, v76, v20
    v_dot2c_f32_bf16 v34, v65, v21
    v_dot2c_f32_bf16 v35, v77, v21
    v_dot2c_f32_bf16 v34, v66, v22
    v_dot2c_f32_bf16 v35, v78, v22
    v_dot2c_f32_bf16 v34, v67, v23
    v_dot2c_f32_bf16 v35, v79, v23
    v_dot2c_f32_bf16 v34, v68, v24
    v_dot2c_f32_bf16 v35, v80, v24
    v_dot2c_f32_bf16 v34, v69, v25
    v_dot2c_f32_bf16 v35, v81, v25
    v_dot2c_f32_bf16 v34, v70, v26
    v_dot2c_f32_bf16 v35, v82, v26
    v_dot2c_f32_bf16 v34, v71, v27
    v_dot2c_f32_bf16 v35, v83, v27
    v_dot2c_f32_bf16 v34, v72, v28
    v_dot2c_f32_bf16 v35, v84, v28
    v_dot2c_f32_bf16 v34, v73, v29
    v_dot2c_f32_bf16 v35, v85, v29
    v_dot2c_f32_bf16 v34, v74, v30
    v_dot2c_f32_bf16 v35, v86, v30
    v_dot2c_f32_bf16 v34, v75, v31
    v_dot2c_f32_bf16 v35, v87, v31
    s_nop 1
    v_add_f32_dpp v34, v34, v34 quad_perm:[1,0,3,2] row_mask:0xf bank_mask:0xf
    v_add_f32_dpp v35, v35, v35 quad_perm:[1,0,3,2] row_mask:0xf bank_mask:0xf
    s_nop 0
    v_add_f32_dpp v34, v34, v34 quad_perm:[2,3,0,1] row_mask:0xf bank_mask:0xf
    v_add_f32_dpp v35, v35, v35 quad_perm:[2,3,0,1] row_mask:0xf bank_mask:0xf
    s_nop 0
    v_add_f32_dpp v34, v34, v34 row_half_mirror row_mask:0xf bank_mask:0xf
    v_add_f32_dpp v35, v35, v35 row_half_mirror row_mask:0xf bank_mask:0xf
    v_cvt_pk_bf16_f32 v15, v34, v35
    v_lshlrev_b32 v34, 16, v15
    v_and_b32 v35, 0xffff0000, v15
    v_mul_f32 v34, 0x3d93cd3a, v34
    v_mul_f32 v35, 0x3d93cd3a, v35
    v_cvt_pk_bf16_f32 v15, v34, v35
    v_lshlrev_b32 v34, 16, v15
    v_and_b32 v35, 0xffff0000, v15
    s_waitcnt vmcnt(3)
    buffer_load_dwordx4 v[232:235], v1, s[12:15], s85 offen offset:0 nt
    v_mov_b32 v36, 0
    v_mov_b32 v37, 0
    v_dot2c_f32_bf16 v36, v88, v20
    v_dot2c_f32_bf16 v37, v100, v20
    v_dot2c_f32_bf16 v36, v89, v21
    v_dot2c_f32_bf16 v37, v101, v21
    v_dot2c_f32_bf16 v36, v90, v22
    v_dot2c_f32_bf16 v37, v102, v22
    v_dot2c_f32_bf16 v36, v91, v23
    v_dot2c_f32_bf16 v37, v103, v23
    v_dot2c_f32_bf16 v36, v92, v24
    v_dot2c_f32_bf16 v37, v104, v24
    v_dot2c_f32_bf16 v36, v93, v25
    v_dot2c_f32_bf16 v37, v105, v25
    v_dot2c_f32_bf16 v36, v94, v26
    v_dot2c_f32_bf16 v37, v106, v26
    v_dot2c_f32_bf16 v36, v95, v27
    v_dot2c_f32_bf16 v37, v107, v27
    v_dot2c_f32_bf16 v36, v96, v28
    v_dot2c_f32_bf16 v37, v108, v28
    v_dot2c_f32_bf16 v36, v97, v29
    v_dot2c_f32_bf16 v37, v109, v29
    v_dot2c_f32_bf16 v36, v98, v30
    v_dot2c_f32_bf16 v37, v110, v30
    v_dot2c_f32_bf16 v36, v99, v31
    v_dot2c_f32_bf16 v37, v111, v31
    s_nop 1
    v_add_f32_dpp v36, v36, v36 quad_perm:[1,0,3,2] row_mask:0xf bank_mask:0xf
    v_add_f32_dpp v37, v37, v37 quad_perm:[1,0,3,2] row_mask:0xf bank_mask:0xf
    s_nop 0
    v_add_f32_dpp v36, v36, v36 quad_perm:[2,3,0,1] row_mask:0xf bank_mask:0xf
    v_add_f32_dpp v37, v37, v37 quad_perm:[2,3,0,1] row_mask:0xf bank_mask:0xf
    s_nop 0
    v_add_f32_dpp v36, v36, v36 row_half_mirror row_mask:0xf bank_mask:0xf
    v_add_f32_dpp v37, v37, v37 row_half_mirror row_mask:0xf bank_mask:0xf
    v_cvt_pk_bf16_f32 v15, v36, v37
    v_lshlrev_b32 v36, 16, v15
    v_and_b32 v37, 0xffff0000, v15
    v_mul_f32 v36, 0x3d93cd3a, v36
    v_mul_f32 v37, 0x3d93cd3a, v37
    v_cvt_pk_bf16_f32 v15, v36, v37
    v_lshlrev_b32 v36, 16, v15
    v_and_b32 v37, 0xffff0000, v15
    v_mov_b32 v38, 0
    v_mov_b32 v39, 0
    v_dot2c_f32_bf16 v38, v112, v20
    v_dot2c_f32_bf16 v39, v124, v20
    v_dot2c_f32_bf16 v38, v113, v21
    v_dot2c_f32_bf16 v39, v125, v21
    v_dot2c_f32_bf16 v38, v114, v22
    v_dot2c_f32_bf16 v39, v126, v22
    v_dot2c_f32_bf16 v38, v115, v23
    v_dot2c_f32_bf16 v39, v127, v23
    v_dot2c_f32_bf16 v38, v116, v24
    v_dot2c_f32_bf16 v39, v128, v24
    v_dot2c_f32_bf16 v38, v117, v25
    v_dot2c_f32_bf16 v39, v129, v25
    v_dot2c_f32_bf16 v38, v118, v26
    v_dot2c_f32_bf16 v39, v130, v26
    v_dot2c_f32_bf16 v38, v119, v27
    v_dot2c_f32_bf16 v39, v131, v27
    v_dot2c_f32_bf16 v38, v120, v28
    v_dot2c_f32_bf16 v39, v132, v28
    v_dot2c_f32_bf16 v38, v121, v29
    v_dot2c_f32_bf16 v39, v133, v29
    v_dot2c_f32_bf16 v38, v122, v30
    v_dot2c_f32_bf16 v39, v134, v30
    v_dot2c_f32_bf16 v38, v123, v31
    v_dot2c_f32_bf16 v39, v135, v31
    s_nop 1
    v_add_f32_dpp v38, v38, v38 quad_perm:[1,0,3,2] row_mask:0xf bank_mask:0xf
    v_add_f32_dpp v39, v39, v39 quad_perm:[1,0,3,2] row_mask:0xf bank_mask:0xf
    s_nop 0
    v_add_f32_dpp v38, v38, v38 quad_perm:[2,3,0,1] row_mask:0xf bank_mask:0xf
    v_add_f32_dpp v39, v39, v39 quad_perm:[2,3,0,1] row_mask:0xf bank_mask:0xf
    s_nop 0
    v_add_f32_dpp v38, v38, v38 row_half_mirror row_mask:0xf bank_mask:0xf
    v_add_f32_dpp v39, v39, v39 row_half_mirror row_mask:0xf bank_mask:0xf
    v_cvt_pk_bf16_f32 v15, v38, v39
    v_lshlrev_b32 v38, 16, v15
    v_and_b32 v39, 0xffff0000, v15
    v_mul_f32 v38, 0x3d93cd3a, v38
    v_mul_f32 v39, 0x3d93cd3a, v39
    v_cvt_pk_bf16_f32 v15, v38, v39
    v_lshlrev_b32 v38, 16, v15
    v_and_b32 v39, 0xffff0000, v15
    s_waitcnt vmcnt(3)
    buffer_load_dwordx4 v[236:239], v1, s[12:15], s85 offen offset:128 nt
    v_mov_b32 v19, 0
    v_dot2c_f32_bf16 v19, v136, v20
    v_dot2c_f32_bf16 v19, v137, v21
    v_dot2c_f32_bf16 v19, v138, v22
    v_dot2c_f32_bf16 v19, v139, v23
    v_dot2c_f32_bf16 v19, v140, v24
    v_dot2c_f32_bf16 v19, v141, v25
    v_dot2c_f32_bf16 v19, v142, v26
    v_dot2c_f32_bf16 v19, v143, v27
    v_dot2c_f32_bf16 v19, v144, v28
    v_dot2c_f32_bf16 v19, v145, v29
    v_dot2c_f32_bf16 v19, v146, v30
    v_dot2c_f32_bf16 v19, v147, v31
    s_nop 2
    v_add_f32_dpp v19, v19, v19 quad_perm:[1,0,3,2] row_mask:0xf bank_mask:0xf
    s_nop 1
    v_add_f32_dpp v19, v19, v19 quad_perm:[2,3,0,1] row_mask:0xf bank_mask:0xf
    s_nop 1
    v_add_f32_dpp v19, v19, v19 row_half_mirror row_mask:0xf bank_mask:0xf
    v_cvt_pk_bf16_f32 v15, v19, v19
    v_lshlrev_b32 v19, 16, v15
    v_mul_f32 v19, 0x3d93cd3a, v19
    v_cvt_pk_bf16_f32 v15, v19, v19
    v_lshlrev_b32 v19, 16, v15
    v_mov_b32 v15, v32
    v_max3_f32 v15, v15, v33, v34
    v_max3_f32 v15, v15, v35, v36
    v_max3_f32 v15, v15, v37, v38
    v_max3_f32 v15, v15, v39, v19
    s_nop 1
    v_max_f32_dpp v15, v15, v15 row_ror:8 row_mask:0xf bank_mask:0xf
    v_mov_b32 v40, 0
    v_mov_b32 v41, 0
    v_mov_b32 v42, 0
    v_mov_b32 v43, 0
    v_mov_b32 v44, 0
    v_mov_b32 v45, 0
    v_mov_b32 v46, 0
    v_mov_b32 v47, 0
    v_mov_b32 v48, 0
    v_mov_b32 v49, 0
    v_mov_b32 v50, 0
    v_mov_b32 v51, 0
    v_mov_b32 v16, v15
    s_nop 1
    v_permlane16_swap_b32 v15, v16
    v_max_f32 v15, v15, v16
    v_mov_b32 v16, v15
    s_nop 1
    v_permlane32_swap_b32 v15, v16
    v_max_f32 v15, v15, v16
    v_mul_f32 v12, 0x3fb8aa3b, v15
    v_and_b32 v17, 1, v2
    v_lshlrev_b32 v17, 4, v17
    v_mov_b32 v18, 0xffff
    v_lshlrev_b32 v18, v17, v18
    v_bfe_u32 v17, v2, 1, 2
    v_cmp_eq_u32 vcc, 0, v17
    s_nop 1
    v_cndmask_b32 v52, 0, v18, vcc
    v_cmp_eq_u32 vcc, 1, v17
    s_nop 1
    v_cndmask_b32 v53, 0, v18, vcc
    v_cmp_eq_u32 vcc, 2, v17
    s_nop 1
    v_cndmask_b32 v54, 0, v18, vcc
    v_cmp_eq_u32 vcc, 3, v17
    s_nop 1
    v_cndmask_b32 v55, 0, v18, vcc
    s_waitcnt vmcnt(3)
    buffer_load_dwordx4 v[240:243], v1, s[12:15], s85 offen offset:256 nt
    s_mov_b32 s62, 0x3fb8aa3b
    v_fma_f32 v32, v32, s62, -v12
    v_fma_f32 v33, v33, s62, -v12
    v_fma_f32 v34, v34, s62, -v12
    v_fma_f32 v35, v35, s62, -v12
    v_fma_f32 v36, v36, s62, -v12
    v_fma_f32 v37, v37, s62, -v12
    v_fma_f32 v38, v38, s62, -v12
    v_fma_f32 v39, v39, s62, -v12
    v_fma_f32 v19, v19, s62, -v12
    v_exp_f32 v32, v32
    v_exp_f32 v33, v33
    v_exp_f32 v34, v34
    v_exp_f32 v35, v35
    v_exp_f32 v36, v36
    v_exp_f32 v37, v37
    v_exp_f32 v38, v38
    v_exp_f32 v39, v39
    v_exp_f32 v19, v19
    v_cvt_pk_bf16_f32 v32, v32, v32
    v_cvt_pk_bf16_f32 v33, v33, v33
    v_cvt_pk_bf16_f32 v34, v34, v34
    v_cvt_pk_bf16_f32 v35, v35, v35
    v_cvt_pk_bf16_f32 v36, v36, v36
    v_cvt_pk_bf16_f32 v37, v37, v37
    v_cvt_pk_bf16_f32 v38, v38, v38
    v_cvt_pk_bf16_f32 v39, v39, v39
    v_cvt_pk_bf16_f32 v19, v19, v19
    v_and_b32 v56, v52, v32
    v_and_b32 v57, v53, v32
    v_and_b32 v58, v54, v32
    v_and_b32 v59, v55, v32
    v_and_b32 v60, v52, v33
    v_and_b32 v61, v53, v33
    v_and_b32 v62, v54, v33
    v_and_b32 v63, v55, v33
    v_and_b32 v64, v52, v34
    v_and_b32 v65, v53, v34
    v_and_b32 v66, v54, v34
    v_and_b32 v67, v55, v34
    v_and_b32 v68, v52, v35
    v_and_b32 v69, v53, v35
    v_and_b32 v70, v54, v35
    v_and_b32 v71, v55, v35
    v_and_b32 v72, v52, v36
    v_and_b32 v73, v53, v36
    v_and_b32 v74, v54, v36
    v_and_b32 v75, v55, v36
    v_and_b32 v76, v52, v37
    v_and_b32 v77, v53, v37
    v_and_b32 v78, v54, v37
    v_and_b32 v79, v55, v37
    v_and_b32 v80, v52, v38
    v_and_b32 v81, v53, v38
    v_and_b32 v82, v54, v38
    v_and_b32 v83, v55, v38
    v_and_b32 v84, v52, v39
    v_and_b32 v85, v53, v39
    v_and_b32 v86, v54, v39
    v_and_b32 v87, v55, v39
    v_and_b32 v88, v52, v19
    v_and_b32 v89, v53, v19
    v_and_b32 v90, v54, v19
    v_and_b32 v91, v55, v19
    s_waitcnt vmcnt(3)
    buffer_load_dwordx4 v[244:247], v1, s[12:15], s86 offen offset:0 nt
    v_and_b32 v13, 0xffff0000, v32
    v_and_b32 v15, 0xffff0000, v33
    v_add_f32 v13, v13, v15
    v_and_b32 v15, 0xffff0000, v34
    v_add_f32 v13, v13, v15
    v_and_b32 v15, 0xffff0000, v35
    v_add_f32 v13, v13, v15
    v_and_b32 v15, 0xffff0000, v36
    v_add_f32 v13, v13, v15
    v_and_b32 v15, 0xffff0000, v37
    v_add_f32 v13, v13, v15
    v_and_b32 v15, 0xffff0000, v38
    v_add_f32 v13, v13, v15
    v_and_b32 v15, 0xffff0000, v39
    v_add_f32 v13, v13, v15
    v_and_b32 v15, 0xffff0000, v19
    v_add_f32 v13, v13, v15
    s_nop 1
    v_add_f32_dpp v13, v13, v13 row_ror:8 row_mask:0xf bank_mask:0xf
    v_mov_b32 v16, v13
    s_nop 1
    v_permlane16_swap_b32 v13, v16
    v_add_f32 v13, v13, v16
    v_mov_b32 v16, v13
    s_nop 1
    v_permlane32_swap_b32 v13, v16
    v_add_f32 v13, v13, v16
    s_lshl_b32 s62, s3, 3
    v_mov_b32 v16, s62
    ds_write_b64 v16, v[12:13] offset:3584
    v_mfma_f32_16x16x32_bf16 v[40:43], v[56:59], v[148:151], v[40:43]
    v_mfma_f32_16x16x32_bf16 v[44:47], v[56:59], v[152:155], v[44:47]
    v_mfma_f32_16x16x32_bf16 v[48:51], v[56:59], v[156:159], v[48:51]
    v_mfma_f32_16x16x32_bf16 v[40:43], v[60:63], v[160:163], v[40:43]
    v_mfma_f32_16x16x32_bf16 v[44:47], v[60:63], v[164:167], v[44:47]
    v_mfma_f32_16x16x32_bf16 v[48:51], v[60:63], v[168:171], v[48:51]
    v_mfma_f32_16x16x32_bf16 v[40:43], v[64:67], v[172:175], v[40:43]
    v_mfma_f32_16x16x32_bf16 v[44:47], v[64:67], v[176:179], v[44:47]
    s_waitcnt vmcnt(3)
    buffer_load_dwordx4 v[248:251], v1, s[12:15], s86 offen offset:128 nt
    v_mfma_f32_16x16x32_bf16 v[48:51], v[64:67], v[180:183], v[48:51]
    v_mfma_f32_16x16x32_bf16 v[40:43], v[68:71], v[184:187], v[40:43]
    v_mfma_f32_16x16x32_bf16 v[44:47], v[68:71], v[188:191], v[44:47]
    v_mfma_f32_16x16x32_bf16 v[48:51], v[68:71], v[192:195], v[48:51]
    v_mfma_f32_16x16x32_bf16 v[40:43], v[72:75], v[196:199], v[40:43]
    v_mfma_f32_16x16x32_bf16 v[44:47], v[72:75], v[200:203], v[44:47]
    v_mfma_f32_16x16x32_bf16 v[48:51], v[72:75], v[204:207], v[48:51]
    v_mfma_f32_16x16x32_bf16 v[40:43], v[76:79], v[208:211], v[40:43]
    v_mfma_f32_16x16x32_bf16 v[44:47], v[76:79], v[212:215], v[44:47]
    v_mfma_f32_16x16x32_bf16 v[48:51], v[76:79], v[216:219], v[48:51]
    v_mfma_f32_16x16x32_bf16 v[40:43], v[80:83], v[220:223], v[40:43]
    v_mfma_f32_16x16x32_bf16 v[44:47], v[80:83], v[224:227], v[44:47]
    v_mfma_f32_16x16x32_bf16 v[48:51], v[80:83], v[228:231], v[48:51]
    v_mfma_f32_16x16x32_bf16 v[40:43], v[84:87], v[232:235], v[40:43]
    s_waitcnt vmcnt(3)
    buffer_load_dwordx4 v[252:255], v1, s[12:15], s86 offen offset:256 nt
    v_mfma_f32_16x16x32_bf16 v[44:47], v[84:87], v[236:239], v[44:47]
    s_waitcnt vmcnt(3)
    buffer_load_dwordx4 v[116:119], v5, s[36:39], s53 offen offset:0 nt
    v_mfma_f32_16x16x32_bf16 v[48:51], v[84:87], v[240:243], v[48:51]
    s_waitcnt vmcnt(3)
    buffer_load_dwordx4 v[120:123], v5, s[36:39], s53 offen offset:1280 nt
    v_mfma_f32_16x16x32_bf16 v[40:43], v[88:91], v[244:247], v[40:43]
    s_waitcnt vmcnt(3)
    buffer_load_dwordx4 v[92:95], v4, s[24:27], s52 offen offset:0 nt
    v_mfma_f32_16x16x32_bf16 v[44:47], v[88:91], v[248:251], v[44:47]
    buffer_load_dwordx4 v[96:99], v4, s[24:27], s52 offen offset:1280 nt
    buffer_load_dwordx4 v[100:103], v4, s[24:27], s52 offen offset:2560 nt
    buffer_load_dwordx4 v[104:107], v4, s[24:27], s52 offen offset:3840 nt
    buffer_load_dwordx4 v[108:111], v4, s[24:27], s64 offen offset:0 nt
    buffer_load_dwordx4 v[112:115], v4, s[24:27], s64 offen offset:1280 nt
    s_waitcnt vmcnt(8)
    v_mfma_f32_16x16x32_bf16 v[48:51], v[88:91], v[252:255], v[48:51]
    s_nop 7
    s_branch L_tail
L_cont24:
    ds_read_b128 v[20:23], v3 offset:2816
    ds_read_b128 v[24:27], v3 offset:2944
    ds_read_b128 v[28:31], v3 offset:3072
    ds_read_b32 v10, v9 offset:3200
    s_waitcnt vmcnt(3)
    buffer_load_dwordx4 v[244:247], v1, s[12:15], s86 offen offset:0 nt
    s_waitcnt lgkmcnt(0)
    v_mov_b32 v32, 0
    v_mov_b32 v33, 0
    v_dot2c_f32_bf16 v32, v40, v20
    v_dot2c_f32_bf16 v33, v52, v20
    v_dot2c_f32_bf16 v32, v41, v21
    v_dot2c_f32_bf16 v33, v53, v21
    v_dot2c_f32_bf16 v32, v42, v22
    v_dot2c_f32_bf16 v33, v54, v22
    v_dot2c_f32_bf16 v32, v43, v23
    v_dot2c_f32_bf16 v33, v55, v23
    v_dot2c_f32_bf16 v32, v44, v24
    v_dot2c_f32_bf16 v33, v56, v24
    v_dot2c_f32_bf16 v32, v45, v25
    v_dot2c_f32_bf16 v33, v57, v25
    v_dot2c_f32_bf16 v32, v46, v26
    v_dot2c_f32_bf16 v33, v58, v26
    v_dot2c_f32_bf16 v32, v47, v27
    v_dot2c_f32_bf16 v33, v59, v27
    v_dot2c_f32_bf16 v32, v48, v28
    v_dot2c_f32_bf16 v33, v60, v28
    v_dot2c_f32_bf16 v32, v49, v29
    v_dot2c_f32_bf16 v33, v61, v29
    v_dot2c_f32_bf16 v32, v50, v30
    v_dot2c_f32_bf16 v33, v62, v30
    v_dot2c_f32_bf16 v32, v51, v31
    v_dot2c_f32_bf16 v33, v63, v31
    s_nop 1
    v_add_f32_dpp v32, v32, v32 quad_perm:[1,0,3,2] row_mask:0xf bank_mask:0xf
    v_add_f32_dpp v33, v33, v33 quad_perm:[1,0,3,2] row_mask:0xf bank_mask:0xf
    s_nop 0
    v_add_f32_dpp v32, v32, v32 quad_perm:[2,3,0,1] row_mask:0xf bank_mask:0xf
    v_add_f32_dpp v33, v33, v33 quad_perm:[2,3,0,1] row_mask:0xf bank_mask:0xf
    s_nop 0
    v_add_f32_dpp v32, v32, v32 row_half_mirror row_mask:0xf bank_mask:0xf
    v_add_f32_dpp v33, v33, v33 row_half_mirror row_mask:0xf bank_mask:0xf
    v_cvt_pk_bf16_f32 v15, v32, v33
    v_lshlrev_b32 v32, 16, v15
    v_and_b32 v33, 0xffff0000, v15
    v_mul_f32 v32, 0x3d93cd3a, v32
    v_mul_f32 v33, 0x3d93cd3a, v33
    v_cvt_pk_bf16_f32 v15, v32, v33
    v_lshlrev_b32 v32, 16, v15
    v_and_b32 v33, 0xffff0000, v15
    v_mov_b32 v34, 0
    v_mov_b32 v35, 0
    v_dot2c_f32_bf16 v34, v64, v20
    v_dot2c_f32_bf16 v35, v76, v20
    v_dot2c_f32_bf16 v34, v65, v21
    v_dot2c_f32_bf16 v35, v77, v21
    v_dot2c_f32_bf16 v34, v66, v22
    v_dot2c_f32_bf16 v35, v78, v22
    v_dot2c_f32_bf16 v34, v67, v23
    v_dot2c_f32_bf16 v35, v79, v23
    v_dot2c_f32_bf16 v34, v68, v24
    v_dot2c_f32_bf16 v35, v80, v24
    v_dot2c_f32_bf16 v34, v69, v25
    v_dot2c_f32_bf16 v35, v81, v25
    v_dot2c_f32_bf16 v34, v70, v26
    v_dot2c_f32_bf16 v35, v82, v26
    v_dot2c_f32_bf16 v34, v71, v27
    v_dot2c_f32_bf16 v35, v83, v27
    v_dot2c_f32_bf16 v34, v72, v28
    v_dot2c_f32_bf16 v35, v84, v28
    v_dot2c_f32_bf16 v34, v73, v29
    v_dot2c_f32_bf16 v35, v85, v29
    v_dot2c_f32_bf16 v34, v74, v30
    v_dot2c_f32_bf16 v35, v86, v30
    v_dot2c_f32_bf16 v34, v75, v31
    v_dot2c_f32_bf16 v35, v87, v31
    s_nop 1
    v_add_f32_dpp v34, v34, v34 quad_perm:[1,0,3,2] row_mask:0xf bank_mask:0xf
    v_add_f32_dpp v35, v35, v35 quad_perm:[1,0,3,2] row_mask:0xf bank_mask:0xf
    s_nop 0
    v_add_f32_dpp v34, v34, v34 quad_perm:[2,3,0,1] row_mask:0xf bank_mask:0xf
    v_add_f32_dpp v35, v35, v35 quad_perm:[2,3,0,1] row_mask:0xf bank_mask:0xf
    s_nop 0
    v_add_f32_dpp v34, v34, v34 row_half_mirror row_mask:0xf bank_mask:0xf
    v_add_f32_dpp v35, v35, v35 row_half_mirror row_mask:0xf bank_mask:0xf
    v_cvt_pk_bf16_f32 v15, v34, v35
    v_lshlrev_b32 v34, 16, v15
    v_and_b32 v35, 0xffff0000, v15
    v_mul_f32 v34, 0x3d93cd3a, v34
    v_mul_f32 v35, 0x3d93cd3a, v35
    v_cvt_pk_bf16_f32 v15, v34, v35
    v_lshlrev_b32 v34, 16, v15
    v_and_b32 v35, 0xffff0000, v15
    s_waitcnt vmcnt(3)
    buffer_load_dwordx4 v[248:251], v1, s[12:15], s86 offen offset:128 nt
    v_mov_b32 v36, 0
    v_mov_b32 v37, 0
    v_dot2c_f32_bf16 v36, v88, v20
    v_dot2c_f32_bf16 v37, v100, v20
    v_dot2c_f32_bf16 v36, v89, v21
    v_dot2c_f32_bf16 v37, v101, v21
    v_dot2c_f32_bf16 v36, v90, v22
    v_dot2c_f32_bf16 v37, v102, v22
    v_dot2c_f32_bf16 v36, v91, v23
    v_dot2c_f32_bf16 v37, v103, v23
    v_dot2c_f32_bf16 v36, v92, v24
    v_dot2c_f32_bf16 v37, v104, v24
    v_dot2c_f32_bf16 v36, v93, v25
    v_dot2c_f32_bf16 v37, v105, v25
    v_dot2c_f32_bf16 v36, v94, v26
    v_dot2c_f32_bf16 v37, v106, v26
    v_dot2c_f32_bf16 v36, v95, v27
    v_dot2c_f32_bf16 v37, v107, v27
    v_dot2c_f32_bf16 v36, v96, v28
    v_dot2c_f32_bf16 v37, v108, v28
    v_dot2c_f32_bf16 v36, v97, v29
    v_dot2c_f32_bf16 v37, v109, v29
    v_dot2c_f32_bf16 v36, v98, v30
    v_dot2c_f32_bf16 v37, v110, v30
    v_dot2c_f32_bf16 v36, v99, v31
    v_dot2c_f32_bf16 v37, v111, v31
    s_nop 1
    v_add_f32_dpp v36, v36, v36 quad_perm:[1,0,3,2] row_mask:0xf bank_mask:0xf
    v_add_f32_dpp v37, v37, v37 quad_perm:[1,0,3,2] row_mask:0xf bank_mask:0xf
    s_nop 0
    v_add_f32_dpp v36, v36, v36 quad_perm:[2,3,0,1] row_mask:0xf bank_mask:0xf
    v_add_f32_dpp v37, v37, v37 quad_perm:[2,3,0,1] row_mask:0xf bank_mask:0xf
    s_nop 0
    v_add_f32_dpp v36, v36, v36 row_half_mirror row_mask:0xf bank_mask:0xf
    v_add_f32_dpp v37, v37, v37 row_half_mirror row_mask:0xf bank_mask:0xf
    v_cvt_pk_bf16_f32 v15, v36, v37
    v_lshlrev_b32 v36, 16, v15
    v_and_b32 v37, 0xffff0000, v15
    v_mul_f32 v36, 0x3d93cd3a, v36
    v_mul_f32 v37, 0x3d93cd3a, v37
    v_cvt_pk_bf16_f32 v15, v36, v37
    v_lshlrev_b32 v36, 16, v15
    v_and_b32 v37, 0xffff0000, v15
    v_mov_b32 v38, 0
    v_mov_b32 v39, 0
    v_dot2c_f32_bf16 v38, v112, v20
    v_dot2c_f32_bf16 v39, v124, v20
    v_dot2c_f32_bf16 v38, v113, v21
    v_dot2c_f32_bf16 v39, v125, v21
    v_dot2c_f32_bf16 v38, v114, v22
    v_dot2c_f32_bf16 v39, v126, v22
    v_dot2c_f32_bf16 v38, v115, v23
    v_dot2c_f32_bf16 v39, v127, v23
    v_dot2c_f32_bf16 v38, v116, v24
    v_dot2c_f32_bf16 v39, v128, v24
    v_dot2c_f32_bf16 v38, v117, v25
    v_dot2c_f32_bf16 v39, v129, v25
    v_dot2c_f32_bf16 v38, v118, v26
    v_dot2c_f32_bf16 v39, v130, v26
    v_dot2c_f32_bf16 v38, v119, v27
    v_dot2c_f32_bf16 v39, v131, v27
    v_dot2c_f32_bf16 v38, v120, v28
    v_dot2c_f32_bf16 v39, v132, v28
    v_dot2c_f32_bf16 v38, v121, v29
    v_dot2c_f32_bf16 v39, v133, v29
    v_dot2c_f32_bf16 v38, v122, v30
    v_dot2c_f32_bf16 v39, v134, v30
    v_dot2c_f32_bf16 v38, v123, v31
    v_dot2c_f32_bf16 v39, v135, v31
    s_nop 1
    v_add_f32_dpp v38, v38, v38 quad_perm:[1,0,3,2] row_mask:0xf bank_mask:0xf
    v_add_f32_dpp v39, v39, v39 quad_perm:[1,0,3,2] row_mask:0xf bank_mask:0xf
    s_nop 0
    v_add_f32_dpp v38, v38, v38 quad_perm:[2,3,0,1] row_mask:0xf bank_mask:0xf
    v_add_f32_dpp v39, v39, v39 quad_perm:[2,3,0,1] row_mask:0xf bank_mask:0xf
    s_nop 0
    v_add_f32_dpp v38, v38, v38 row_half_mirror row_mask:0xf bank_mask:0xf
    v_add_f32_dpp v39, v39, v39 row_half_mirror row_mask:0xf bank_mask:0xf
    v_cvt_pk_bf16_f32 v15, v38, v39
    v_lshlrev_b32 v38, 16, v15
    v_and_b32 v39, 0xffff0000, v15
    v_mul_f32 v38, 0x3d93cd3a, v38
    v_mul_f32 v39, 0x3d93cd3a, v39
    v_cvt_pk_bf16_f32 v15, v38, v39
    v_lshlrev_b32 v38, 16, v15
    v_and_b32 v39, 0xffff0000, v15
    s_waitcnt vmcnt(3)
    buffer_load_dwordx4 v[252:255], v1, s[12:15], s86 offen offset:256 nt
    v_mov_b32 v19, 0
    v_dot2c_f32_bf16 v19, v136, v20
    v_dot2c_f32_bf16 v19, v137, v21
    v_dot2c_f32_bf16 v19, v138, v22
    v_dot2c_f32_bf16 v19, v139, v23
    v_dot2c_f32_bf16 v19, v140, v24
    v_dot2c_f32_bf16 v19, v141, v25
    v_dot2c_f32_bf16 v19, v142, v26
    v_dot2c_f32_bf16 v19, v143, v27
    v_dot2c_f32_bf16 v19, v144, v28
    v_dot2c_f32_bf16 v19, v145, v29
    v_dot2c_f32_bf16 v19, v146, v30
    v_dot2c_f32_bf16 v19, v147, v31
    s_nop 2
    v_add_f32_dpp v19, v19, v19 quad_perm:[1,0,3,2] row_mask:0xf bank_mask:0xf
    s_nop 1
    v_add_f32_dpp v19, v19, v19 quad_perm:[2,3,0,1] row_mask:0xf bank_mask:0xf
    s_nop 1
    v_add_f32_dpp v19, v19, v19 row_half_mirror row_mask:0xf bank_mask:0xf
    v_cvt_pk_bf16_f32 v15, v19, v19
    v_lshlrev_b32 v19, 16, v15
    v_mul_f32 v19, 0x3d93cd3a, v19
    v_cvt_pk_bf16_f32 v15, v19, v19
    v_lshlrev_b32 v19, 16, v15
    v_mov_b32 v15, v32
    v_max3_f32 v15, v15, v33, v34
    v_max3_f32 v15, v15, v35, v36
    v_max3_f32 v15, v15, v37, v38
    v_max3_f32 v15, v15, v39, v19
    s_nop 1
    v_max_f32_dpp v15, v15, v15 row_ror:8 row_mask:0xf bank_mask:0xf
    v_mov_b32 v40, 0
    v_mov_b32 v41, 0
    v_mov_b32 v42, 0
    v_mov_b32 v43, 0
    v_mov_b32 v44, 0
    v_mov_b32 v45, 0
    v_mov_b32 v46, 0
    v_mov_b32 v47, 0
    v_mov_b32 v48, 0
    v_mov_b32 v49, 0
    v_mov_b32 v50, 0
    v_mov_b32 v51, 0
    v_mov_b32 v16, v15
    s_nop 1
    v_permlane16_swap_b32 v15, v16
    v_max_f32 v15, v15, v16
    v_mov_b32 v16, v15
    s_nop 1
    v_permlane32_swap_b32 v15, v16
    v_max_f32 v15, v15, v16
    v_mul_f32 v12, 0x3fb8aa3b, v15
    v_and_b32 v17, 1, v2
    v_lshlrev_b32 v17, 4, v17
    v_mov_b32 v18, 0xffff
    v_lshlrev_b32 v18, v17, v18
    v_bfe_u32 v17, v2, 1, 2
    v_cmp_eq_u32 vcc, 0, v17
    s_nop 1
    v_cndmask_b32 v52, 0, v18, vcc
    v_cmp_eq_u32 vcc, 1, v17
    s_nop 1
    v_cndmask_b32 v53, 0, v18, vcc
    v_cmp_eq_u32 vcc, 2, v17
    s_nop 1
    v_cndmask_b32 v54, 0, v18, vcc
    v_cmp_eq_u32 vcc, 3, v17
    s_nop 1
    v_cndmask_b32 v55, 0, v18, vcc
    s_mov_b32 s62, 0x3fb8aa3b
    v_fma_f32 v32, v32, s62, -v12
    v_fma_f32 v33, v33, s62, -v12
    v_fma_f32 v34, v34, s62, -v12
    v_fma_f32 v35, v35, s62, -v12
    v_fma_f32 v36, v36, s62, -v12
    v_fma_f32 v37, v37, s62, -v12
    v_fma_f32 v38, v38, s62, -v12
    v_fma_f32 v39, v39, s62, -v12
    v_fma_f32 v19, v19, s62, -v12
    v_exp_f32 v32, v32
    v_exp_f32 v33, v33
    v_exp_f32 v34, v34
    v_exp_f32 v35, v35
    v_exp_f32 v36, v36
    v_exp_f32 v37, v37
    v_exp_f32 v38, v38
    v_exp_f32 v39, v39
    v_exp_f32 v19, v19
    v_cvt_pk_bf16_f32 v32, v32, v32
    v_cvt_pk_bf16_f32 v33, v33, v33
    v_cvt_pk_bf16_f32 v34, v34, v34
    v_cvt_pk_bf16_f32 v35, v35, v35
    v_cvt_pk_bf16_f32 v36, v36, v36
    v_cvt_pk_bf16_f32 v37, v37, v37
    v_cvt_pk_bf16_f32 v38, v38, v38
    v_cvt_pk_bf16_f32 v39, v39, v39
    v_cvt_pk_bf16_f32 v19, v19, v19
    v_and_b32 v56, v52, v32
    v_and_b32 v57, v53, v32
    v_and_b32 v58, v54, v32
    v_and_b32 v59, v55, v32
    v_and_b32 v60, v52, v33
    v_and_b32 v61, v53, v33
    v_and_b32 v62, v54, v33
    v_and_b32 v63, v55, v33
    v_and_b32 v64, v52, v34
    v_and_b32 v65, v53, v34
    v_and_b32 v66, v54, v34
    v_and_b32 v67, v55, v34
    v_and_b32 v68, v52, v35
    v_and_b32 v69, v53, v35
    v_and_b32 v70, v54, v35
    v_and_b32 v71, v55, v35
    v_and_b32 v72, v52, v36
    v_and_b32 v73, v53, v36
    v_and_b32 v74, v54, v36
    v_and_b32 v75, v55, v36
    v_and_b32 v76, v52, v37
    v_and_b32 v77, v53, v37
    v_and_b32 v78, v54, v37
    v_and_b32 v79, v55, v37
    v_and_b32 v80, v52, v38
    v_and_b32 v81, v53, v38
    v_and_b32 v82, v54, v38
    v_and_b32 v83, v55, v38
    v_and_b32 v84, v52, v39
    v_and_b32 v85, v53, v39
    v_and_b32 v86, v54, v39
    v_and_b32 v87, v55, v39
    v_and_b32 v88, v52, v19
    v_and_b32 v89, v53, v19
    v_and_b32 v90, v54, v19
    v_and_b32 v91, v55, v19
    s_waitcnt vmcnt(3)
    buffer_load_dwordx4 v[116:119], v5, s[36:39], s53 offen offset:0 nt
    v_and_b32 v13, 0xffff0000, v32
    v_and_b32 v15, 0xffff0000, v33
    v_add_f32 v13, v13, v15
    v_and_b32 v15, 0xffff0000, v34
    v_add_f32 v13, v13, v15
    v_and_b32 v15, 0xffff0000, v35
    v_add_f32 v13, v13, v15
    v_and_b32 v15, 0xffff0000, v36
    v_add_f32 v13, v13, v15
    v_and_b32 v15, 0xffff0000, v37
    v_add_f32 v13, v13, v15
    v_and_b32 v15, 0xffff0000, v38
    v_add_f32 v13, v13, v15
    v_and_b32 v15, 0xffff0000, v39
    v_add_f32 v13, v13, v15
    v_and_b32 v15, 0xffff0000, v19
    v_add_f32 v13, v13, v15
    s_nop 1
    v_add_f32_dpp v13, v13, v13 row_ror:8 row_mask:0xf bank_mask:0xf
    v_mov_b32 v16, v13
    s_nop 1
    v_permlane16_swap_b32 v13, v16
    v_add_f32 v13, v13, v16
    v_mov_b32 v16, v13
    s_nop 1
    v_permlane32_swap_b32 v13, v16
    v_add_f32 v13, v13, v16
    s_lshl_b32 s62, s3, 3
    v_mov_b32 v16, s62
    ds_write_b64 v16, v[12:13] offset:3584
    v_mfma_f32_16x16x32_bf16 v[40:43], v[56:59], v[148:151], v[40:43]
    v_mfma_f32_16x16x32_bf16 v[44:47], v[56:59], v[152:155], v[44:47]
    v_mfma_f32_16x16x32_bf16 v[48:51], v[56:59], v[156:159], v[48:51]
    v_mfma_f32_16x16x32_bf16 v[40:43], v[60:63], v[160:163], v[40:43]
    v_mfma_f32_16x16x32_bf16 v[44:47], v[60:63], v[164:167], v[44:47]
    v_mfma_f32_16x16x32_bf16 v[48:51], v[60:63], v[168:171], v[48:51]
    v_mfma_f32_16x16x32_bf16 v[40:43], v[64:67], v[172:175], v[40:43]
    v_mfma_f32_16x16x32_bf16 v[44:47], v[64:67], v[176:179], v[44:47]
    s_waitcnt vmcnt(3)
    buffer_load_dwordx4 v[120:123], v5, s[36:39], s53 offen offset:1280 nt
    v_mfma_f32_16x16x32_bf16 v[48:51], v[64:67], v[180:183], v[48:51]
    v_mfma_f32_16x16x32_bf16 v[40:43], v[68:71], v[184:187], v[40:43]
    v_mfma_f32_16x16x32_bf16 v[44:47], v[68:71], v[188:191], v[44:47]
    v_mfma_f32_16x16x32_bf16 v[48:51], v[68:71], v[192:195], v[48:51]
    v_mfma_f32_16x16x32_bf16 v[40:43], v[72:75], v[196:199], v[40:43]
    v_mfma_f32_16x16x32_bf16 v[44:47], v[72:75], v[200:203], v[44:47]
    v_mfma_f32_16x16x32_bf16 v[48:51], v[72:75], v[204:207], v[48:51]
    v_mfma_f32_16x16x32_bf16 v[40:43], v[76:79], v[208:211], v[40:43]
    v_mfma_f32_16x16x32_bf16 v[44:47], v[76:79], v[212:215], v[44:47]
    v_mfma_f32_16x16x32_bf16 v[48:51], v[76:79], v[216:219], v[48:51]
    v_mfma_f32_16x16x32_bf16 v[40:43], v[80:83], v[220:223], v[40:43]
    v_mfma_f32_16x16x32_bf16 v[44:47], v[80:83], v[224:227], v[44:47]
    v_mfma_f32_16x16x32_bf16 v[48:51], v[80:83], v[228:231], v[48:51]
    v_mfma_f32_16x16x32_bf16 v[40:43], v[84:87], v[232:235], v[40:43]
    v_mfma_f32_16x16x32_bf16 v[44:47], v[84:87], v[236:239], v[44:47]
    v_mfma_f32_16x16x32_bf16 v[48:51], v[84:87], v[240:243], v[48:51]
    s_waitcnt vmcnt(3)
    buffer_load_dwordx4 v[92:95], v4, s[24:27], s52 offen offset:0 nt
    v_mfma_f32_16x16x32_bf16 v[40:43], v[88:91], v[244:247], v[40:43]
    v_mfma_f32_16x16x32_bf16 v[44:47], v[88:91], v[248:251], v[44:47]
    buffer_load_dwordx4 v[96:99], v4, s[24:27], s52 offen offset:1280 nt
    buffer_load_dwordx4 v[100:103], v4, s[24:27], s52 offen offset:2560 nt
    buffer_load_dwordx4 v[104:107], v4, s[24:27], s52 offen offset:3840 nt
    buffer_load_dwordx4 v[108:111], v4, s[24:27], s64 offen offset:0 nt
    buffer_load_dwordx4 v[112:115], v4, s[24:27], s64 offen offset:1280 nt
    s_waitcnt vmcnt(8)
    v_mfma_f32_16x16x32_bf16 v[48:51], v[88:91], v[252:255], v[48:51]
    s_nop 7
    s_branch L_tail
L_aux:
    s_setprio 2
    v_mov_b32 v16, 3328
    v_mov_b32 v17, 0
    ds_write_b32 v16, v17
    v_mul_u32_u24 v4, 122880, v15
    v_add_u32 v4, v4, v3
    v_mul_u32_u24 v5, 30720, v15
    v_add_u32 v5, v5, v3
    v_mul_u32_u24 v7, 20, v15
    s_add_u32 s78, s76, 193536
    s_mul_i32 s79, s5, 160
    s_mul_i32 s80, s5, 983040
    s_mul_i32 s77, s4, 384
    s_add_u32 s80, s80, s77
    s_mul_i32 s81, s5, 245760
    s_lshl_b32 s77, s4, 7
    s_add_u32 s81, s81, s77
    s_cmp_lt_u32 s4, 24
    s_cselect_b32 s81, s81, 1073741824
    s_lshl_b32 s82, s2, 9
    s_add_u32 s82, s82, 393216
    v_lshlrev_b32 v14, 3, v2
    s_lshl_b32 s83, s4, 13
    s_lshl_b32 s77, s5, 8
    s_add_u32 s83, s83, s77
    s_add_u32 s83, s83, 524288
    v_lshrrev_b32 v12, 4, v2
    v_lshlrev_b32 v12, 11, v12
    v_and_b32 v13, 15, v2
    v_lshl_add_u32 v12, v13, 4, v12
    s_lshl_b32 s84, s4, 2
    s_add_u32 s84, s84, s6
    s_mul_i32 s84, s84, 2560
    s_mul_i32 s77, s7, 1280
    s_add_u32 s84, s84, s77
    s_add_u32 s84, s84, 2097152
    s_getreg_b32 s85, hwreg(HW_REG_XCC_ID)
    s_and_b32 s85, s85, 15
    s_mul_i32 s77, s85, s85
    s_lshl_b32 s77, s77, 12
    s_lshl_b32 s85, s85, 4
    s_add_u32 s85, s85, s77
    s_add_u32 s85, s85, 1
    v_and_b32 v16, 1, v2
    v_lshlrev_b32 v16, 4, v16
    v_mov_b32 v17, 0xffff
    v_lshlrev_b32 v17, v16, v17
    v_bfe_u32 v16, v2, 1, 2
    v_cmp_eq_u32 vcc, 0, v16
    s_nop 1
    v_cndmask_b32 v8, 0, v17, vcc
    v_cmp_eq_u32 vcc, 1, v16
    s_nop 1
    v_cndmask_b32 v9, 0, v17, vcc
    v_cmp_eq_u32 vcc, 2, v16
    s_nop 1
    v_cndmask_b32 v10, 0, v17, vcc
    v_cmp_eq_u32 vcc, 3, v16
    s_nop 1
    v_cndmask_b32 v11, 0, v17, vcc
    v_mov_b32 v52, -1
    v_mov_b32 v53, -1
    v_mov_b32 v54, -1
    v_mov_b32 v55, -1
    s_waitcnt lgkmcnt(0)
    s_mov_b32 s16, s74
    s_mov_b32 s17, s75
    s_mov_b32 s18, 1610612736
    s_mov_b32 s19, 0x00020000
    s_mov_b32 s48, s72
    s_mov_b32 s49, s73
    s_mov_b32 s50, 256
    s_mov_b32 s51, 0x00020000
    buffer_store_dwordx2 v[52:53], v14, s[16:19], s82 offen sc1 nt
    buffer_store_dwordx4 v[52:55], v12, s[16:19], s83 offen sc1 nt
    s_mov_b32 s40, s52
    s_mov_b32 s41, s53
    s_mov_b32 s42, 1280
    s_mov_b32 s43, 0x00020000
    s_mov_b32 s20, s58
    s_mov_b32 s21, s59
    s_mov_b32 s22, 7864320
    s_mov_b32 s23, 0x00020000
    buffer_load_dwordx4 v[32:35], v6, s[40:43], 0 offen
    buffer_load_dwordx4 v[36:39], v6, s[40:43], 0 offen offset:1024
    buffer_load_dwordx4 v[16:19], v7, s[40:43], s79 offen
    buffer_load_dword v15, v7, s[40:43], s79 offen offset:16
    s_mov_b32 s28, s64
    s_mov_b32 s29, s65
    s_mov_b32 s30, 1966080
    s_mov_b32 s31, 0x00020000
    s_mov_b32 s32, s66
    s_mov_b32 s33, s67
    s_mov_b32 s34, 1966080
    s_mov_b32 s35, 0x00020000
    buffer_load_dwordx4 v[56:59], v4, s[20:23], s80 offen offset:0 nt
    buffer_load_dwordx4 v[60:63], v4, s[20:23], s80 offen offset:128 nt
    buffer_load_dwordx4 v[64:67], v4, s[20:23], s80 offen offset:256 nt
    buffer_load_dwordx4 v[68:71], v5, s[28:31], s81 offen nt
    buffer_load_dwordx4 v[72:75], v5, s[32:35], s81 offen nt
    s_add_u32 s80, s80, 12288
    s_add_u32 s81, s81, 3072
    buffer_load_dwordx4 v[76:79], v4, s[20:23], s80 offen offset:0 nt
    buffer_load_dwordx4 v[80:83], v4, s[20:23], s80 offen offset:128 nt
    buffer_load_dwordx4 v[84:87], v4, s[20:23], s80 offen offset:256 nt
    buffer_load_dwordx4 v[88:91], v5, s[28:31], s81 offen nt
    buffer_load_dwordx4 v[92:95], v5, s[32:35], s81 offen nt
    s_add_u32 s80, s80, 12288
    s_add_u32 s81, s81, 3072
    buffer_load_dwordx4 v[96:99], v4, s[20:23], s80 offen offset:0 nt
    buffer_load_dwordx4 v[100:103], v4, s[20:23], s80 offen offset:128 nt
    buffer_load_dwordx4 v[104:107], v4, s[20:23], s80 offen offset:256 nt
    buffer_load_dwordx4 v[108:111], v5, s[28:31], s81 offen nt
    buffer_load_dwordx4 v[112:115], v5, s[32:35], s81 offen nt
    s_add_u32 s80, s80, 12288
    s_add_u32 s81, s81, 3072
    buffer_load_dwordx4 v[116:119], v4, s[20:23], s80 offen offset:0 nt
    buffer_load_dwordx4 v[120:123], v4, s[20:23], s80 offen offset:128 nt
    buffer_load_dwordx4 v[124:127], v4, s[20:23], s80 offen offset:256 nt
    buffer_load_dwordx4 v[128:131], v5, s[28:31], s81 offen nt
    buffer_load_dwordx4 v[132:135], v5, s[32:35], s81 offen nt
    s_add_u32 s80, s80, 12288
    s_add_u32 s81, s81, 3072
    buffer_load_dwordx4 v[136:139], v4, s[20:23], s80 offen offset:0 nt
    buffer_load_dwordx4 v[140:143], v4, s[20:23], s80 offen offset:128 nt
    buffer_load_dwordx4 v[144:147], v4, s[20:23], s80 offen offset:256 nt
    buffer_load_dwordx4 v[148:151], v5, s[28:31], s81 offen nt
    buffer_load_dwordx4 v[152:155], v5, s[32:35], s81 offen nt
    s_add_u32 s80, s80, 12288
    s_add_u32 s81, s81, 3072
    buffer_load_dwordx4 v[156:159], v4, s[20:23], s80 offen offset:0 nt
    buffer_load_dwordx4 v[160:163], v4, s[20:23], s80 offen offset:128 nt
    buffer_load_dwordx4 v[164:167], v4, s[20:23], s80 offen offset:256 nt
    buffer_load_dwordx4 v[168:171], v5, s[28:31], s81 offen nt
    buffer_load_dwordx4 v[172:175], v5, s[32:35], s81 offen nt
    s_add_u32 s80, s80, 12288
    s_add_u32 s81, s81, 3072
    buffer_load_dwordx4 v[176:179], v4, s[20:23], s80 offen offset:0 nt
    buffer_load_dwordx4 v[180:183], v4, s[20:23], s80 offen offset:128 nt
    buffer_load_dwordx4 v[184:187], v4, s[20:23], s80 offen offset:256 nt
    buffer_load_dwordx4 v[188:191], v5, s[28:31], s81 offen nt
    buffer_load_dwordx4 v[192:195], v5, s[32:35], s81 offen nt
    s_add_u32 s80, s80, 12288
    s_add_u32 s81, s81, 3072
    buffer_load_dwordx4 v[196:199], v4, s[20:23], s80 offen offset:0 nt
    buffer_load_dwordx4 v[200:203], v4, s[20:23], s80 offen offset:128 nt
    buffer_load_dwordx4 v[204:207], v4, s[20:23], s80 offen offset:256 nt
    buffer_load_dwordx4 v[208:211], v5, s[28:31], s81 offen nt
    buffer_load_dwordx4 v[212:215], v5, s[32:35], s81 offen nt
    s_add_u32 s80, s80, 12288
    s_add_u32 s81, s81, 3072
    buffer_load_dwordx4 v[216:219], v4, s[20:23], s80 offen offset:0 nt
    buffer_load_dwordx4 v[220:223], v4, s[20:23], s80 offen offset:128 nt
    buffer_load_dwordx4 v[224:227], v4, s[20:23], s80 offen offset:256 nt
    buffer_load_dwordx4 v[228:231], v5, s[28:31], s81 offen nt
    buffer_load_dwordx4 v[232:235], v5, s[32:35], s81 offen nt
    s_add_u32 s80, s80, 12288
    s_add_u32 s81, s81, 3072
    buffer_load_dwordx4 v[236:239], v4, s[20:23], s80 offen offset:0 nt
    buffer_load_dwordx4 v[240:243], v4, s[20:23], s80 offen offset:128 nt
    buffer_load_dwordx4 v[244:247], v4, s[20:23], s80 offen offset:256 nt
    buffer_load_dwordx4 v[248:251], v5, s[28:31], s81 offen nt
    buffer_load_dwordx4 v[252:255], v5, s[32:35], s81 offen nt
    s_barrier
    s_mov_b32 s8, s54
    s_mov_b32 s9, s55
    s_mov_b32 s10, 402653184
    s_mov_b32 s11, 0x00020000
    s_mov_b32 s12, s56
    s_mov_b32 s13, s57
    s_mov_b32 s14, 402653184
    s_mov_b32 s15, 0x00020000
    s_mov_b32 s16, s74
    s_mov_b32 s17, s75
    s_mov_b32 s18, 1610612736
    s_mov_b32 s19, 0x00020000
    s_mov_b32 s24, s60
    s_mov_b32 s25, s61
    s_mov_b32 s26, 7864320
    s_mov_b32 s27, 0x00020000
    s_mov_b32 s36, s68
    s_mov_b32 s37, s69
    s_mov_b32 s38, 1966080
    s_mov_b32 s39, 0x00020000
    s_mov_b32 s44, s70
    s_mov_b32 s45, s71
    s_mov_b32 s46, 1280
    s_mov_b32 s47, 0x00020000
    s_mov_b32 s48, s72
    s_mov_b32 s49, s73
    s_mov_b32 s50, 256
    s_mov_b32 s51, 0x00020000
    s_mov_b32 s40, s52
    s_mov_b32 s41, s53
    s_mov_b32 s42, 1280
    s_mov_b32 s43, 0x00020000
    s_mul_i32 s52, s4, 192
    s_mul_i32 s63, s6, 48
    s_add_u32 s52, s52, s63
    s_mul_i32 s52, s52, 1280
    s_mul_i32 s63, s7, 640
    s_add_u32 s52, s52, s63
    s_lshl_b32 s53, s4, 6
    s_lshl_b32 s62, s6, 4
    s_add_u32 s53, s53, s62
    s_mul_i32 s53, s53, 1280
    s_add_u32 s53, s53, s63
    s_cmp_lt_u32 s4, 24
    s_cselect_b32 s53, s53, 1073741824
    s_sub_u32 s62, s3, 1
    s_cmp_lt_u32 s62, 4
    s_cselect_b32 s62, s62, 8
    s_cmp_eq_u32 s3, 7
    s_cselect_b32 s62, 4, s62
    s_lshl_b32 s63, s62, 7
    s_cmp_lt_u32 s62, 5
    s_cselect_b32 s63, s63, 1073741824
    s_add_u32 s52, s52, s63
    s_add_u32 s53, s53, s63
    s_add_u32 s64, s52, 5120
    s_lshl_b32 s65, s62, 8
    s_lshl_b32 s54, s4, 13
    s_add_u32 s54, s54, 524288
    s_lshl_b32 s62, s6, 11
    s_add_u32 s55, s54, s62
    s_lshl_b32 s62, s5, 8
    s_add_u32 s56, s54, s62
    s_mul_i32 s57, s4, 10240
    s_add_u32 s57, s57, 2097152
    s_lshl_b32 s58, s4, 2
    s_add_u32 s58, s58, s6
    s_mul_i32 s58, s58, 2560
    s_mul_i32 s62, s7, 1280
    s_add_u32 s58, s58, s62
    s_add_u32 s58, s58, 2097152
    s_add_u32 s58, s58, s65
    s_mul_i32 s59, s4, 10240
    s_mul_i32 s62, s5, 1280
    s_add_u32 s59, s59, s62
    s_add_u32 s59, s59, 2097152
    s_and_b32 s62, s4, 16
    s_add_u32 s62, s62, s4
    s_lshl_b32 s62, s62, 2
    v_mov_b32 v12, s62
    v_mov_b32 v13, s85
    s_waitcnt vmcnt(50)
    v_lshlrev_b32 v20, 16, v16
    v_and_b32 v21, 0xffff0000, v16
    v_lshlrev_b32 v22, 16, v17
    v_and_b32 v23, 0xffff0000, v17
    v_lshlrev_b32 v24, 16, v18
    v_and_b32 v25, 0xffff0000, v18
    v_lshlrev_b32 v26, 16, v19
    v_and_b32 v27, 0xffff0000, v19
    v_lshlrev_b32 v28, 16, v15
    v_and_b32 v29, 0xffff0000, v15
    v_lshlrev_b32 v40, 16, v32
    v_and_b32 v41, 0xffff0000, v32
    v_lshlrev_b32 v42, 16, v33
    v_and_b32 v43, 0xffff0000, v33
    v_lshlrev_b32 v44, 16, v34
    v_and_b32 v45, 0xffff0000, v34
    v_lshlrev_b32 v46, 16, v35
    v_and_b32 v47, 0xffff0000, v35
    v_lshlrev_b32 v48, 16, v36
    v_and_b32 v49, 0xffff0000, v36
    v_lshlrev_b32 v50, 16, v37
    v_and_b32 v51, 0xffff0000, v37
    v_lshlrev_b32 v52, 16, v38
    v_and_b32 v53, 0xffff0000, v38
    v_lshlrev_b32 v54, 16, v39
    v_and_b32 v55, 0xffff0000, v39
    v_add_f32 v15, v40, v41
    v_add_f32 v15, v15, v42
    v_add_f32 v15, v15, v43
    v_add_f32 v15, v15, v44
    v_add_f32 v15, v15, v45
    v_add_f32 v15, v15, v46
    v_add_f32 v15, v15, v47
    v_add_f32 v15, v15, v48
    v_add_f32 v15, v15, v49
    v_add_f32 v15, v15, v50
    v_add_f32 v15, v15, v51
    v_add_f32 v15, v15, v52
    v_add_f32 v15, v15, v53
    v_add_f32 v15, v15, v54
    v_add_f32 v15, v15, v55
    s_nop 1
    v_add_f32_dpp v15, v15, v15 quad_perm:[1,0,3,2] row_mask:0xf bank_mask:0xf
    s_nop 1
    v_add_f32_dpp v15, v15, v15 quad_perm:[2,3,0,1] row_mask:0xf bank_mask:0xf
    s_nop 1
    v_add_f32_dpp v15, v15, v15 row_half_mirror row_mask:0xf bank_mask:0xf
    s_nop 1
    v_add_f32_dpp v15, v15, v15 row_mirror row_mask:0xf bank_mask:0xf
    s_nop 0
    v_readlane_b32 s60, v15, 0
    v_readlane_b32 s61, v15, 16
    v_readlane_b32 s62, v15, 32
    v_readlane_b32 s63, v15, 48
    v_mov_b32 v15, s60
    v_add_f32 v15, s61, v15
    v_add_f32 v15, s62, v15
    v_add_f32 v15, s63, v15
    v_mul_f32 v15, 0x3acccccd, v15
    v_mov_b32 v16, 0
    v_sub_f32 v17, v40, v15
    v_fmac_f32 v16, v17, v17
    v_sub_f32 v17, v41, v15
    v_fmac_f32 v16, v17, v17
    v_sub_f32 v17, v42, v15
    v_fmac_f32 v16, v17, v17
    v_sub_f32 v17, v43, v15
    v_fmac_f32 v16, v17, v17
    v_sub_f32 v17, v44, v15
    v_fmac_f32 v16, v17, v17
    v_sub_f32 v17, v45, v15
    v_fmac_f32 v16, v17, v17
    v_sub_f32 v17, v46, v15
    v_fmac_f32 v16, v17, v17
    v_sub_f32 v17, v47, v15
    v_fmac_f32 v16, v17, v17
    s_mov_b64 exec, 0xffff
    v_sub_f32 v17, v48, v15
    v_fmac_f32 v16, v17, v17
    v_sub_f32 v17, v49, v15
    v_fmac_f32 v16, v17, v17
    v_sub_f32 v17, v50, v15
    v_fmac_f32 v16, v17, v17
    v_sub_f32 v17, v51, v15
    v_fmac_f32 v16, v17, v17
    v_sub_f32 v17, v52, v15
    v_fmac_f32 v16, v17, v17
    v_sub_f32 v17, v53, v15
    v_fmac_f32 v16, v17, v17
    v_sub_f32 v17, v54, v15
    v_fmac_f32 v16, v17, v17
    v_sub_f32 v17, v55, v15
    v_fmac_f32 v16, v17, v17
    s_mov_b64 exec, -1
    s_nop 0
    v_add_f32_dpp v16, v16, v16 quad_perm:[1,0,3,2] row_mask:0xf bank_mask:0xf
    s_nop 1
    v_add_f32_dpp v16, v16, v16 quad_perm:[2,3,0,1] row_mask:0xf bank_mask:0xf
    s_nop 1
    v_add_f32_dpp v16, v16, v16 row_half_mirror row_mask:0xf bank_mask:0xf
    s_nop 1
    v_add_f32_dpp v16, v16, v16 row_mirror row_mask:0xf bank_mask:0xf
    s_nop 0
    v_readlane_b32 s60, v16, 0
    v_readlane_b32 s61, v16, 16
    v_readlane_b32 s62, v16, 32
    v_readlane_b32 s63, v16, 48
    v_mov_b32 v16, s60
    v_add_f32 v16, s61, v16
    v_add_f32 v16, s62, v16
    v_add_f32 v16, s63, v16
    v_mul_f32 v16, 0x3acccccd, v16
    v_cvt_pk_bf16_f32 v17, v15, v16
    v_lshlrev_b32 v15, 16, v17
    v_and_b32 v16, 0xffff0000, v17
    v_add_f32 v16, 0x3727c5ac, v16
    v_cvt_pk_bf16_f32 v16, v16, v16
    v_lshlrev_b32 v16, 16, v16
    v_sqrt_f32 v16, v16
    s_nop 0
    v_cvt_pk_bf16_f32 v16, v16, v16
    v_lshlrev_b32 v16, 16, v16
    v_rcp_f32 v17, v16
    v_sub_f32 v20, v20, v15
    v_sub_f32 v21, v21, v15
    v_sub_f32 v22, v22, v15
    v_sub_f32 v23, v23, v15
    v_sub_f32 v24, v24, v15
    v_sub_f32 v25, v25, v15
    v_sub_f32 v26, v26, v15
    v_sub_f32 v27, v27, v15
    v_sub_f32 v28, v28, v15
    v_sub_f32 v29, v29, v15
    v_cvt_pk_bf16_f32 v18, v20, v21
    v_lshlrev_b32 v20, 16, v18
    v_and_b32 v21, 0xffff0000, v18
    v_cvt_pk_bf16_f32 v18, v22, v23
    v_lshlrev_b32 v22, 16, v18
    v_and_b32 v23, 0xffff0000, v18
    v_cvt_pk_bf16_f32 v18, v24, v25
    v_lshlrev_b32 v24, 16, v18
    v_and_b32 v25, 0xffff0000, v18
    v_cvt_pk_bf16_f32 v18, v26, v27
    v_lshlrev_b32 v26, 16, v18
    v_and_b32 v27, 0xffff0000, v18
    v_cvt_pk_bf16_f32 v18, v28, v29
    v_lshlrev_b32 v28, 16, v18
    v_and_b32 v29, 0xffff0000, v18
    v_mul_f32 v18, v20, v17
    v_fma_f32 v19, -v18, v16, v20
    v_fma_f32 v20, v19, v17, v18
    v_mul_f32 v18, v21, v17
    v_fma_f32 v19, -v18, v16, v21
    v_fma_f32 v21, v19, v17, v18
    v_mul_f32 v18, v22, v17
    v_fma_f32 v19, -v18, v16, v22
    v_fma_f32 v22, v19, v17, v18
    v_mul_f32 v18, v23, v17
    v_fma_f32 v19, -v18, v16, v23
    v_fma_f32 v23, v19, v17, v18
    v_mul_f32 v18, v24, v17
    v_fma_f32 v19, -v18, v16, v24
    v_fma_f32 v24, v19, v17, v18
    v_mul_f32 v18, v25, v17
    v_fma_f32 v19, -v18, v16, v25
    v_fma_f32 v25, v19, v17, v18
    v_mul_f32 v18, v26, v17
    v_fma_f32 v19, -v18, v16, v26
    v_fma_f32 v26, v19, v17, v18
    v_mul_f32 v18, v27, v17
    v_fma_f32 v19, -v18, v16, v27
    v_fma_f32 v27, v19, v17, v18
    v_mul_f32 v18, v28, v17
    v_fma_f32 v19, -v18, v16, v28
    v_fma_f32 v28, v19, v17, v18
    v_mul_f32 v18, v29, v17
    v_fma_f32 v19, -v18, v16, v29
    v_fma_f32 v29, v19, v17, v18
    v_cvt_pk_bf16_f32 v20, v20, v20
    v_cvt_pk_bf16_f32 v21, v21, v21
    v_cvt_pk_bf16_f32 v22, v22, v22
    v_cvt_pk_bf16_f32 v23, v23, v23
    v_cvt_pk_bf16_f32 v24, v24, v24
    v_cvt_pk_bf16_f32 v25, v25, v25
    v_cvt_pk_bf16_f32 v26, v26, v26
    v_cvt_pk_bf16_f32 v27, v27, v27
    v_cvt_pk_bf16_f32 v28, v28, v28
    v_cvt_pk_bf16_f32 v29, v29, v29
    v_mov_b32 v32, 0
    v_mov_b32 v33, 0
    v_mov_b32 v34, 0
    v_mov_b32 v35, 0
    v_mov_b32 v36, 0
    v_mov_b32 v37, 0
    v_mov_b32 v38, 0
    v_mov_b32 v39, 0
    v_mov_b32 v40, 0
    v_mov_b32 v41, 0
    v_mov_b32 v42, 0
    v_mov_b32 v43, 0
    v_mov_b32 v44, 0
    v_mov_b32 v45, 0
    v_mov_b32 v46, 0
    v_mov_b32 v47, 0
    v_mov_b32 v48, 0
    v_mov_b32 v49, 0
    v_mov_b32 v50, 0
    v_mov_b32 v51, 0
    v_lshrrev_b32 v15, 5, v2
    v_mul_u32_u24 v15, 1280, v15
    v_and_b32 v16, 16, v2
    v_lshl_add_u32 v16, v3, 1, v16
    v_add_u32 v15, v15, v16
    v_lshlrev_b32 v14, 3, v2
    v_and_b32 v52, v8, v20
    v_and_b32 v53, v9, v20
    v_and_b32 v54, v10, v20
    v_and_b32 v55, v11, v20
    s_waitcnt vmcnt(45)
    s_nop 0
    v_mfma_f32_16x16x32_bf16 v[32:35], v[52:55], v[56:59], v[32:35]
    v_mfma_f32_16x16x32_bf16 v[36:39], v[52:55], v[60:63], v[36:39]
    v_mfma_f32_16x16x32_bf16 v[40:43], v[52:55], v[64:67], v[40:43]
    v_mfma_f32_16x16x32_bf16 v[44:47], v[52:55], v[68:71], v[44:47]
    v_mfma_f32_16x16x32_bf16 v[48:51], v[52:55], v[72:75], v[48:51]
    v_and_b32 v52, v8, v21
    v_and_b32 v53, v9, v21
    v_and_b32 v54, v10, v21
    v_and_b32 v55, v11, v21
    s_waitcnt vmcnt(40)
    s_nop 0
    v_mfma_f32_16x16x32_bf16 v[32:35], v[52:55], v[76:79], v[32:35]
    v_mfma_f32_16x16x32_bf16 v[36:39], v[52:55], v[80:83], v[36:39]
    v_mfma_f32_16x16x32_bf16 v[40:43], v[52:55], v[84:87], v[40:43]
    v_mfma_f32_16x16x32_bf16 v[44:47], v[52:55], v[88:91], v[44:47]
    v_mfma_f32_16x16x32_bf16 v[48:51], v[52:55], v[92:95], v[48:51]
    v_and_b32 v52, v8, v22
    v_and_b32 v53, v9, v22
    v_and_b32 v54, v10, v22
    v_and_b32 v55, v11, v22
    s_waitcnt vmcnt(35)
    s_nop 0
    v_mfma_f32_16x16x32_bf16 v[32:35], v[52:55], v[96:99], v[32:35]
    v_mfma_f32_16x16x32_bf16 v[36:39], v[52:55], v[100:103], v[36:39]
    v_mfma_f32_16x16x32_bf16 v[40:43], v[52:55], v[104:107], v[40:43]
    v_mfma_f32_16x16x32_bf16 v[44:47], v[52:55], v[108:111], v[44:47]
    v_mfma_f32_16x16x32_bf16 v[48:51], v[52:55], v[112:115], v[48:51]
    v_and_b32 v52, v8, v23
    v_and_b32 v53, v9, v23
    v_and_b32 v54, v10, v23
    v_and_b32 v55, v11, v23
    s_waitcnt vmcnt(30)
    s_nop 0
    v_mfma_f32_16x16x32_bf16 v[32:35], v[52:55], v[116:119], v[32:35]
    v_mfma_f32_16x16x32_bf16 v[36:39], v[52:55], v[120:123], v[36:39]
    v_mfma_f32_16x16x32_bf16 v[40:43], v[52:55], v[124:127], v[40:43]
    v_mfma_f32_16x16x32_bf16 v[44:47], v[52:55], v[128:131], v[44:47]
    v_mfma_f32_16x16x32_bf16 v[48:51], v[52:55], v[132:135], v[48:51]
    v_and_b32 v52, v8, v24
    v_and_b32 v53, v9, v24
    v_and_b32 v54, v10, v24
    v_and_b32 v55, v11, v24
    s_waitcnt vmcnt(25)
    s_nop 0
    v_mfma_f32_16x16x32_bf16 v[32:35], v[52:55], v[136:139], v[32:35]
    v_mfma_f32_16x16x32_bf16 v[36:39], v[52:55], v[140:143], v[36:39]
    v_mfma_f32_16x16x32_bf16 v[40:43], v[52:55], v[144:147], v[40:43]
    v_mfma_f32_16x16x32_bf16 v[44:47], v[52:55], v[148:151], v[44:47]
    v_mfma_f32_16x16x32_bf16 v[48:51], v[52:55], v[152:155], v[48:51]
    v_and_b32 v52, v8, v25
    v_and_b32 v53, v9, v25
    v_and_b32 v54, v10, v25
    v_and_b32 v55, v11, v25
    s_waitcnt vmcnt(20)
    s_nop 0
    v_mfma_f32_16x16x32_bf16 v[32:35], v[52:55], v[156:159], v[32:35]
    v_mfma_f32_16x16x32_bf16 v[36:39], v[52:55], v[160:163], v[36:39]
    v_mfma_f32_16x16x32_bf16 v[40:43], v[52:55], v[164:167], v[40:43]
    v_mfma_f32_16x16x32_bf16 v[44:47], v[52:55], v[168:171], v[44:47]
    v_mfma_f32_16x16x32_bf16 v[48:51], v[52:55], v[172:175], v[48:51]
    v_and_b32 v52, v8, v26
    v_and_b32 v53, v9, v26
    v_and_b32 v54, v10, v26
    v_and_b32 v55, v11, v26
    s_waitcnt vmcnt(15)
    s_nop 0
    v_mfma_f32_16x16x32_bf16 v[32:35], v[52:55], v[176:179], v[32:35]
    v_mfma_f32_16x16x32_bf16 v[36:39], v[52:55], v[180:183], v[36:39]
    v_mfma_f32_16x16x32_bf16 v[40:43], v[52:55], v[184:187], v[40:43]
    v_mfma_f32_16x16x32_bf16 v[44:47], v[52:55], v[188:191], v[44:47]
    v_mfma_f32_16x16x32_bf16 v[48:51], v[52:55], v[192:195], v[48:51]
    v_and_b32 v52, v8, v27
    v_and_b32 v53, v9, v27
    v_and_b32 v54, v10, v27
    v_and_b32 v55, v11, v27
    s_waitcnt vmcnt(10)
    s_nop 0
    v_mfma_f32_16x16x32_bf16 v[32:35], v[52:55], v[196:199], v[32:35]
    v_mfma_f32_16x16x32_bf16 v[36:39], v[52:55], v[200:203], v[36:39]
    v_mfma_f32_16x16x32_bf16 v[40:43], v[52:55], v[204:207], v[40:43]
    v_mfma_f32_16x16x32_bf16 v[44:47], v[52:55], v[208:211], v[44:47]
    v_mfma_f32_16x16x32_bf16 v[48:51], v[52:55], v[212:215], v[48:51]
    v_and_b32 v52, v8, v28
    v_and_b32 v53, v9, v28
    v_and_b32 v54, v10, v28
    v_and_b32 v55, v11, v28
    s_waitcnt vmcnt(5)
    s_nop 0
    v_mfma_f32_16x16x32_bf16 v[32:35], v[52:55], v[216:219], v[32:35]
    v_mfma_f32_16x16x32_bf16 v[36:39], v[52:55], v[220:223], v[36:39]
    v_mfma_f32_16x16x32_bf16 v[40:43], v[52:55], v[224:227], v[40:43]
    v_mfma_f32_16x16x32_bf16 v[44:47], v[52:55], v[228:231], v[44:47]
    v_mfma_f32_16x16x32_bf16 v[48:51], v[52:55], v[232:235], v[48:51]
    v_and_b32 v52, v8, v29
    v_and_b32 v53, v9, v29
    v_and_b32 v54, v10, v29
    v_and_b32 v55, v11, v29
    s_waitcnt vmcnt(0)
    s_nop 0
    v_mfma_f32_16x16x32_bf16 v[32:35], v[52:55], v[236:239], v[32:35]
    v_mfma_f32_16x16x32_bf16 v[36:39], v[52:55], v[240:243], v[36:39]
    v_mfma_f32_16x16x32_bf16 v[40:43], v[52:55], v[244:247], v[40:43]
    v_mfma_f32_16x16x32_bf16 v[44:47], v[52:55], v[248:251], v[44:47]
    v_mfma_f32_16x16x32_bf16 v[48:51], v[52:55], v[252:255], v[48:51]
    s_mov_b32 exec_lo, 0x00ff00ff
    s_mov_b32 exec_hi, 0xff00ff00
    s_nop 1
    ds_write_b128 v15, v[32:35] offset:0
    ds_write_b128 v15, v[36:39] offset:256
    ds_write_b128 v15, v[40:43] offset:512
    ds_write_b128 v15, v[44:47] offset:768
    ds_write_b128 v15, v[48:51] offset:1024
    s_mov_b64 exec, -1
    s_waitcnt lgkmcnt(0)
    ds_read_b128 v[64:67], v6 offset:0
    ds_read_b128 v[68:71], v6 offset:1280
    ds_read_b128 v[72:75], v6 offset:256
    ds_read_b128 v[76:79], v6 offset:1536
    s_waitcnt lgkmcnt(0)
    v_add_f32 v64, v64, v68
    v_add_f32 v72, v72, v76
    v_add_f32 v65, v65, v69
    v_add_f32 v73, v73, v77
    v_add_f32 v66, v66, v70
    v_add_f32 v74, v74, v78
    v_add_f32 v67, v67, v71
    v_add_f32 v75, v75, v79
    v_and_b32 v64, -2, v64
    v_and_b32 v72, -2, v72
    v_and_b32 v65, -2, v65
    v_and_b32 v73, -2, v73
    v_and_b32 v66, -2, v66
    v_and_b32 v74, -2, v74
    v_and_b32 v67, -2, v67
    v_and_b32 v75, -2, v75
    buffer_store_dwordx4 v[64:67], v6, s[16:19], s59 offen sc1
    s_mov_b32 exec_lo, 0
    s_mov_b32 exec_hi, 0xffff0000
    buffer_store_dwordx4 v[72:75], v6, s[16:19], s59 offen offset:256 sc1
    s_mov_b64 exec, -1
    s_mov_b64 exec, 1
    s_waitcnt vmcnt(0)
    buffer_atomic_add v13, v12, s[48:51], 0 offen sc0
    s_waitcnt vmcnt(0)
    v_readfirstlane_b32 s62, v13
    s_mov_b64 exec, -1
    s_mul_i32 s63, s85, 7
    s_cmp_eq_u32 s62, s63
    s_cselect_b32 s66, 2, 1
    s_add_u32 s67, s6, 1
    s_and_b32 s67, s67, 3
    s_lshl_b32 s67, s67, 2
    s_add_u32 s67, s67, 48
    s_and_b32 s62, s62, 7
    s_cmp_eq_u32 s62, 7
    s_cbranch_scc0 L_await
    s_add_u32 s60, s57, 3840
    s_add_u32 s61, s57, 7680
    buffer_load_dwordx4 v[96:99], v6, s[16:19], s57 offen offset:0 sc1
    buffer_load_dwordx4 v[100:103], v6, s[16:19], s57 offen offset:1280 sc1
    buffer_load_dwordx4 v[104:107], v6, s[16:19], s57 offen offset:2560 sc1
    buffer_load_dwordx4 v[108:111], v6, s[16:19], s60 offen offset:0 sc1
    buffer_load_dwordx4 v[112:115], v6, s[16:19], s60 offen offset:1280 sc1
    buffer_load_dwordx4 v[116:119], v6, s[16:19], s60 offen offset:2560 sc1
    buffer_load_dwordx4 v[120:123], v6, s[16:19], s61 offen offset:0 sc1
    buffer_load_dwordx4 v[124:127], v6, s[16:19], s61 offen offset:1280 sc1
    s_mov_b32 exec_lo, 0
    s_mov_b32 exec_hi, 0xffff0000
    buffer_load_dwordx4 v[160:163], v6, s[16:19], s57 offen offset:256 sc1
    buffer_load_dwordx4 v[164:167], v6, s[16:19], s57 offen offset:1536 sc1
    buffer_load_dwordx4 v[168:171], v6, s[16:19], s57 offen offset:2816 sc1
    buffer_load_dwordx4 v[172:175], v6, s[16:19], s60 offen offset:256 sc1
    buffer_load_dwordx4 v[176:179], v6, s[16:19], s60 offen offset:1536 sc1
    buffer_load_dwordx4 v[180:183], v6, s[16:19], s60 offen offset:2816 sc1
    buffer_load_dwordx4 v[184:187], v6, s[16:19], s61 offen offset:256 sc1
    buffer_load_dwordx4 v[188:191], v6, s[16:19], s61 offen offset:1536 sc1
    s_mov_b64 exec, -1
    s_waitcnt vmcnt(0)
L_agot:
    v_add_f32 v96, v96, v100
    v_add_f32 v160, v160, v164
    v_add_f32 v97, v97, v101
    v_add_f32 v161, v161, v165
    v_add_f32 v98, v98, v102
    v_add_f32 v162, v162, v166
    v_add_f32 v99, v99, v103
    v_add_f32 v163, v163, v167
    v_add_f32 v96, v96, v104
    v_add_f32 v160, v160, v168
    v_add_f32 v97, v97, v105
    v_add_f32 v161, v161, v169
    v_add_f32 v98, v98, v106
    v_add_f32 v162, v162, v170
    v_add_f32 v99, v99, v107
    v_add_f32 v163, v163, v171
    v_add_f32 v96, v96, v108
    v_add_f32 v160, v160, v172
    v_add_f32 v97, v97, v109
    v_add_f32 v161, v161, v173
    v_add_f32 v98, v98, v110
    v_add_f32 v162, v162, v174
    v_add_f32 v99, v99, v111
    v_add_f32 v163, v163, v175
    v_add_f32 v96, v96, v112
    v_add_f32 v160, v160, v176
    v_add_f32 v97, v97, v113
    v_add_f32 v161, v161, v177
    v_add_f32 v98, v98, v114
    v_add_f32 v162, v162, v178
    v_add_f32 v99, v99, v115
    v_add_f32 v163, v163, v179
    v_add_f32 v96, v96, v116
    v_add_f32 v160, v160, v180
    v_add_f32 v97, v97, v117
    v_add_f32 v161, v161, v181
    v_add_f32 v98, v98, v118
    v_add_f32 v162, v162, v182
    v_add_f32 v99, v99, v119
    v_add_f32 v163, v163, v183
    v_add_f32 v96, v96, v120
    v_add_f32 v160, v160, v184
    v_add_f32 v97, v97, v121
    v_add_f32 v161, v161, v185
    v_add_f32 v98, v98, v122
    v_add_f32 v162, v162, v186
    v_add_f32 v99, v99, v123
    v_add_f32 v163, v163, v187
    v_add_f32 v96, v96, v124
    v_add_f32 v160, v160, v188
    v_add_f32 v97, v97, v125
    v_add_f32 v161, v161, v189
    v_add_f32 v98, v98, v126
    v_add_f32 v162, v162, v190
    v_add_f32 v99, v99, v127
    v_add_f32 v163, v163, v191
    v_cvt_pk_bf16_f32 v20, v96, v97
    v_cvt_pk_bf16_f32 v21, v98, v99
    v_cvt_pk_bf16_f32 v22, v160, v161
    v_cvt_pk_bf16_f32 v23, v162, v163
    s_mov_b32 exec_lo, 0
    s_mov_b32 exec_hi, 0xffff0000
    v_lshlrev_b32 v64, 16, v20
    v_and_b32 v65, 0xffff0000, v20
    v_lshlrev_b32 v66, 16, v21
    v_and_b32 v67, 0xffff0000, v21
    v_lshlrev_b32 v160, 16, v22
    v_and_b32 v161, 0xffff0000, v22
    v_lshlrev_b32 v162, 16, v23
    v_and_b32 v163, 0xffff0000, v23
    v_mul_f32 v68, 0xbfb8aa3b, v64
    v_mul_f32 v69, 0xbfb8aa3b, v65
    v_mul_f32 v70, 0xbfb8aa3b, v66
    v_mul_f32 v71, 0xbfb8aa3b, v67
    v_exp_f32 v68, v68
    v_exp_f32 v69, v69
    v_exp_f32 v70, v70
    v_exp_f32 v71, v71
    v_add_f32 v68, 1.0, v68
    v_add_f32 v69, 1.0, v69
    v_add_f32 v70, 1.0, v70
    v_add_f32 v71, 1.0, v71
    v_rcp_f32 v72, v68
    v_rcp_f32 v73, v69
    v_rcp_f32 v74, v70
    v_rcp_f32 v75, v71
    v_mul_f32 v76, v64, v72
    v_mul_f32 v77, v65, v73
    v_mul_f32 v78, v66, v74
    v_mul_f32 v79, v67, v75
    v_cvt_pk_bf16_f32 v20, v76, v77
    v_cvt_pk_bf16_f32 v21, v78, v79
    v_lshlrev_b32 v64, 16, v20
    v_and_b32 v65, 0xffff0000, v20
    v_lshlrev_b32 v66, 16, v21
    v_and_b32 v67, 0xffff0000, v21
    v_mul_f32 v64, v64, v160
    v_mul_f32 v65, v65, v161
    v_mul_f32 v66, v66, v162
    v_mul_f32 v67, v67, v163
    v_cvt_pk_bf16_f32 v20, v64, v65
    v_cvt_pk_bf16_f32 v21, v66, v67
    s_mov_b64 exec, -1
    v_min_u32 v20, -2, v20
    v_min_u32 v21, -2, v21
    s_lshl_b32 s62, s4, 9
    s_add_u32 s62, s62, 393216
    v_mov_b32 v24, v20
    v_mov_b32 v25, v21
    v_writelane_b32 v24, s66, 52
    v_mov_b32 v26, v20
    v_mov_b32 v27, v21
    v_writelane_b32 v26, s66, 56
    v_mov_b32 v28, v20
    v_mov_b32 v29, v21
    v_writelane_b32 v28, s66, 60
    v_mov_b32 v30, v20
    v_mov_b32 v31, v21
    v_writelane_b32 v30, s66, 48
    s_cmp_eq_u32 s66, 2
    s_nop 0
    s_cbranch_scc1 L_pushL
    buffer_store_dwordx2 v[24:25], v14, s[16:19], s62 offen sc1
    s_add_u32 s62, s62, 16384
    buffer_store_dwordx2 v[24:25], v14, s[16:19], s62 offen sc1
    s_add_u32 s62, s62, 16384
    buffer_store_dwordx2 v[26:27], v14, s[16:19], s62 offen sc1
    s_add_u32 s62, s62, 16384
    buffer_store_dwordx2 v[26:27], v14, s[16:19], s62 offen sc1
    s_add_u32 s62, s62, 16384
    buffer_store_dwordx2 v[28:29], v14, s[16:19], s62 offen sc1
    s_add_u32 s62, s62, 16384
    buffer_store_dwordx2 v[28:29], v14, s[16:19], s62 offen sc1
    s_add_u32 s62, s62, 16384
    buffer_store_dwordx2 v[30:31], v14, s[16:19], s62 offen sc1
    s_add_u32 s62, s62, 16384
    buffer_store_dwordx2 v[30:31], v14, s[16:19], s62 offen sc1
    s_branch L_atake
L_pushL:
    buffer_store_dwordx2 v[24:25], v14, s[16:19], s62 offen
    s_add_u32 s62, s62, 16384
    buffer_store_dwordx2 v[24:25], v14, s[16:19], s62 offen
    s_add_u32 s62, s62, 16384
    buffer_store_dwordx2 v[26:27], v14, s[16:19], s62 offen
    s_add_u32 s62, s62, 16384
    buffer_store_dwordx2 v[26:27], v14, s[16:19], s62 offen
    s_add_u32 s62, s62, 16384
    buffer_store_dwordx2 v[28:29], v14, s[16:19], s62 offen
    s_add_u32 s62, s62, 16384
    buffer_store_dwordx2 v[28:29], v14, s[16:19], s62 offen
    s_add_u32 s62, s62, 16384
    buffer_store_dwordx2 v[30:31], v14, s[16:19], s62 offen
    s_add_u32 s62, s62, 16384
    buffer_store_dwordx2 v[30:31], v14, s[16:19], s62 offen
    s_branch L_atake
L_await:
    s_sleep 96
    s_mov_b32 s63, 1048576
L_aspin:
    buffer_load_dwordx2 v[20:21], v14, s[16:19], s82 offen sc1
    s_waitcnt vmcnt(0)
    v_max_u32 v22, v20, v21
    v_cmp_eq_u32 vcc, -1, v22
    s_cmp_eq_u64 vcc, 0
    s_nop 3
    s_cbranch_scc1 L_agotq
    s_sub_u32 s63, s63, 1
    s_cmp_eq_u32 s63, 0
    s_cbranch_scc1 L_agotq
    s_sleep 24
    s_branch L_aspin
L_agotq:
    v_readlane_b32 s66, v20, s67
    s_cmp_eq_u32 s66, 2
    s_cselect_b32 s66, 2, 1
    s_nop 2
L_atake:
    ds_write_b64 v14, v[20:21] offset:2816
    v_mov_b32 v22, 3328
    v_mov_b32 v23, s66
    s_waitcnt lgkmcnt(0)
    ds_write_b32 v22, v23
    s_setprio 0
    buffer_load_dwordx4 v[160:163], v1, s[8:11], s78 offen offset:0 nt
    buffer_load_dwordx4 v[164:167], v1, s[8:11], s78 offen offset:128 nt
    buffer_load_dwordx4 v[168:171], v1, s[8:11], s78 offen offset:256 nt
    buffer_load_dwordx4 v[148:151], v1, s[12:15], s78 offen offset:0 nt
    buffer_load_dwordx4 v[152:155], v1, s[12:15], s78 offen offset:128 nt
    buffer_load_dwordx4 v[156:159], v1, s[12:15], s78 offen offset:256 nt
    v_lshrrev_b32 v15, 3, v2
    v_mul_u32_u24 v4, 7680, v15
    v_add_u32 v4, v4, v3
    v_mul_u32_u24 v5, 2560, v15
    v_add_u32 v5, v5, v3
    v_lshlrev_b32 v9, 2, v15
    s_lshl_b32 s87, s6, 5
    v_add_u32 v9, s87, v9
    v_lshlrev_b32 v8, 4, v3
    v_mul_u32_u24 v7, 24, v15
    v_and_b32 v16, 16, v2
    v_lshl_add_u32 v11, v3, 1, v16
    v_lshrrev_b32 v15, 5, v2
    v_mul_u32_u24 v15, 768, v15
    s_mul_i32 s87, s3, 1536
    v_add3_u32 v14, v11, v15, s87
    buffer_load_dwordx4 v[116:119], v5, s[36:39], s53 offen offset:0 nt
    buffer_load_dwordx4 v[120:123], v5, s[36:39], s53 offen offset:1280 nt
    buffer_load_dwordx4 v[92:95], v4, s[24:27], s52 offen offset:0 nt
    buffer_load_dwordx4 v[96:99], v4, s[24:27], s52 offen offset:1280 nt
    buffer_load_dwordx4 v[100:103], v4, s[24:27], s52 offen offset:2560 nt
    buffer_load_dwordx4 v[104:107], v4, s[24:27], s52 offen offset:3840 nt
    buffer_load_dwordx4 v[108:111], v4, s[24:27], s64 offen offset:0 nt
    buffer_load_dwordx4 v[112:115], v4, s[24:27], s64 offen offset:1280 nt
    ds_read_b128 v[20:23], v3 offset:2816
    ds_read_b128 v[24:27], v3 offset:2944
    ds_read_b128 v[28:31], v3 offset:3072
    ds_read_b32 v10, v9 offset:3200
    s_waitcnt vmcnt(11)
    s_waitcnt lgkmcnt(0)
    v_mov_b32 v32, 0
    v_dot2c_f32_bf16 v32, v160, v20
    v_dot2c_f32_bf16 v32, v161, v21
    v_dot2c_f32_bf16 v32, v162, v22
    v_dot2c_f32_bf16 v32, v163, v23
    v_dot2c_f32_bf16 v32, v164, v24
    v_dot2c_f32_bf16 v32, v165, v25
    v_dot2c_f32_bf16 v32, v166, v26
    v_dot2c_f32_bf16 v32, v167, v27
    v_dot2c_f32_bf16 v32, v168, v28
    v_dot2c_f32_bf16 v32, v169, v29
    v_dot2c_f32_bf16 v32, v170, v30
    v_dot2c_f32_bf16 v32, v171, v31
    s_nop 2
    v_add_f32_dpp v32, v32, v32 quad_perm:[1,0,3,2] row_mask:0xf bank_mask:0xf
    s_nop 1
    v_add_f32_dpp v32, v32, v32 quad_perm:[2,3,0,1] row_mask:0xf bank_mask:0xf
    s_nop 1
    v_add_f32_dpp v32, v32, v32 row_half_mirror row_mask:0xf bank_mask:0xf
    v_cvt_pk_bf16_f32 v15, v32, v32
    v_lshlrev_b32 v32, 16, v15
    v_mul_f32 v32, 0x3d93cd3a, v32
    v_cvt_pk_bf16_f32 v15, v32, v32
    v_lshlrev_b32 v32, 16, v15
    v_mov_b32 v15, v32
    s_nop 1
    v_max_f32_dpp v15, v15, v15 row_ror:8 row_mask:0xf bank_mask:0xf
    v_mov_b32 v40, 0
    v_mov_b32 v41, 0
    v_mov_b32 v42, 0
    v_mov_b32 v43, 0
    v_mov_b32 v44, 0
    v_mov_b32 v45, 0
    v_mov_b32 v46, 0
    v_mov_b32 v47, 0
    v_mov_b32 v48, 0
    v_mov_b32 v49, 0
    v_mov_b32 v50, 0
    v_mov_b32 v51, 0
    v_mov_b32 v16, v15
    s_nop 1
    v_permlane16_swap_b32 v15, v16
    v_max_f32 v15, v15, v16
    v_mov_b32 v16, v15
    s_nop 1
    v_permlane32_swap_b32 v15, v16
    v_max_f32 v15, v15, v16
    v_mul_f32 v12, 0x3fb8aa3b, v15
    v_and_b32 v17, 1, v2
    v_lshlrev_b32 v17, 4, v17
    v_mov_b32 v18, 0xffff
    v_lshlrev_b32 v18, v17, v18
    v_bfe_u32 v17, v2, 1, 2
    v_cmp_eq_u32 vcc, 0, v17
    s_nop 1
    v_cndmask_b32 v52, 0, v18, vcc
    v_cmp_eq_u32 vcc, 1, v17
    s_nop 1
    v_cndmask_b32 v53, 0, v18, vcc
    v_cmp_eq_u32 vcc, 2, v17
    s_nop 1
    v_cndmask_b32 v54, 0, v18, vcc
    v_cmp_eq_u32 vcc, 3, v17
    s_nop 1
    v_cndmask_b32 v55, 0, v18, vcc
    s_mov_b32 s62, 0x3fb8aa3b
    v_fma_f32 v32, v32, s62, -v12
    v_exp_f32 v32, v32
    s_nop 0
    v_cvt_pk_bf16_f32 v32, v32, v32
    v_and_b32 v56, v52, v32
    v_and_b32 v57, v53, v32
    v_and_b32 v58, v54, v32
    v_and_b32 v59, v55, v32
    v_and_b32 v13, 0xffff0000, v32
    s_nop 1
    v_add_f32_dpp v13, v13, v13 row_ror:8 row_mask:0xf bank_mask:0xf
    v_mov_b32 v16, v13
    s_nop 1
    v_permlane16_swap_b32 v13, v16
    v_add_f32 v13, v13, v16
    v_mov_b32 v16, v13
    s_nop 1
    v_permlane32_swap_b32 v13, v16
    v_add_f32 v13, v13, v16
    s_lshl_b32 s62, s3, 3
    v_mov_b32 v16, s62
    ds_write_b64 v16, v[12:13] offset:3584
    s_waitcnt vmcnt(8)
    v_mfma_f32_16x16x32_bf16 v[40:43], v[56:59], v[148:151], v[40:43]
    v_mfma_f32_16x16x32_bf16 v[44:47], v[56:59], v[152:155], v[44:47]
    v_mfma_f32_16x16x32_bf16 v[48:51], v[56:59], v[156:159], v[48:51]
    s_cmp_ge_u32 s2, 20
    s_nop 6
    s_cbranch_scc1 L_acntok
    v_and_b32 v15, 15, v2
    v_and_b32 v16, 16, v2
    v_lshl_add_u32 v15, v16, 1, v15
    v_lshlrev_b32 v15, 2, v15
    s_mov_b32 s63, 1048576
    s_nop 0
L_cnt:
    buffer_load_dword v16, v15, s[48:51], 0 offen sc1
    s_waitcnt vmcnt(0)
    v_and_b32 v17, 7, v16
    v_cmp_ne_u32 vcc, 0, v17
    v_cmp_eq_u32 s[60:61], 0, v16
    s_or_b64 vcc, vcc, s[60:61]
    s_cmp_eq_u64 vcc, 0
    s_nop 2
    s_cbranch_scc1 L_acntok
    s_sub_u32 s63, s63, 1
    s_cmp_eq_u32 s63, 0
    s_cbranch_scc1 L_acntok
    s_sleep 16
    s_branch L_cnt
L_acntok:
L_tail:
    s_mov_b32 exec_lo, 0x00ff00ff
    s_mov_b32 exec_hi, 0xff00ff00
    ds_write_b128 v14, v[40:43] offset:3712
    ds_write_b128 v14, v[44:47] offset:3968
    ds_write_b128 v14, v[48:51] offset:4224
    s_mov_b64 exec, -1
    s_cmp_eq_u32 s3, 0
    s_cbranch_scc1 L_w0
    s_cmp_eq_u32 s3, 7
    s_cbranch_scc1 L_w7
    s_waitcnt lgkmcnt(0)
    s_barrier
    v_and_b32 v16, 0xffff, v10
    v_lshl_or_b32 v16, v16, 16, v16
    v_lshrrev_b32 v17, 16, v10
    v_lshl_or_b32 v17, v17, 16, v17
    v_mov_b32 v124, 0
    v_mov_b32 v125, 0
    v_mov_b32 v126, 0
    v_mov_b32 v127, 0
    v_and_b32 v28, v52, v16
    v_and_b32 v29, v53, v16
    v_and_b32 v30, v54, v16
    v_and_b32 v31, v55, v16
    v_and_b32 v32, v52, v17
    v_and_b32 v33, v53, v17
    v_and_b32 v34, v54, v17
    v_and_b32 v35, v55, v17
    s_waitcnt vmcnt(0)
    v_mfma_f32_16x16x32_bf16 v[124:127], v[28:31], v[116:119], v[124:127]
    v_mfma_f32_16x16x32_bf16 v[124:127], v[32:35], v[120:123], v[124:127]
    s_nop 7
    s_branch L_b3b
L_w7:
    v_and_b32 v16, 0xffff, v10
    v_lshl_or_b32 v16, v16, 16, v16
    v_lshrrev_b32 v17, 16, v10
    v_lshl_or_b32 v17, v17, 16, v17
    v_mov_b32 v124, 0
    v_mov_b32 v125, 0
    v_mov_b32 v126, 0
    v_mov_b32 v127, 0
    v_and_b32 v28, v52, v16
    v_and_b32 v29, v53, v16
    v_and_b32 v30, v54, v16
    v_and_b32 v31, v55, v16
    v_and_b32 v32, v52, v17
    v_and_b32 v33, v53, v17
    v_and_b32 v34, v54, v17
    v_and_b32 v35, v55, v17
    s_waitcnt vmcnt(0)
    v_mfma_f32_16x16x32_bf16 v[124:127], v[28:31], v[116:119], v[124:127]
    v_mfma_f32_16x16x32_bf16 v[124:127], v[32:35], v[120:123], v[124:127]
    v_lshrrev_b32 v20, 3, v2
    v_lshlrev_b32 v20, 8, v20
    v_add_u32 v21, v20, v3
    v_and_b32 v22, 48, v3
    v_add_u32 v22, v20, v22
    v_and_b32 v24, 48, v3
    v_add_u32 v24, 128, v24
    v_cmp_gt_u32 vcc, 32, v2
    s_nop 1
    v_cndmask_b32 v23, v24, v3, vcc
    v_bfe_u32 v24, v2, 4, 1
    v_lshl_add_u32 v23, v24, 3, v23
    s_mov_b32 s63, 1048576
    s_waitcnt lgkmcnt(0)
    s_barrier
L_chk1:
    buffer_load_dwordx4 v[128:131], v21, s[16:19], s55 offen sc1
    buffer_load_dwordx4 v[132:135], v22, s[16:19], s55 offen offset:128 sc1
    buffer_load_dwordx2 v[136:137], v20, s[16:19], s55 offen offset:192 sc1
    s_waitcnt vmcnt(0)
    v_max3_u32 v64, v128, v129, v130
    v_max3_u32 v64, v64, v131, v132
    v_max3_u32 v64, v64, v133, v134
    v_max3_u32 v64, v64, v135, v136
    v_max_u32 v64, v64, v137
    v_cmp_eq_u32 vcc, -1, v64
    s_cmp_eq_u64 vcc, 0
    s_nop 3
    s_cbranch_scc1 L_go1
    s_sub_u32 s63, s63, 1
    s_cmp_lg_u32 s63, 0
    s_cbranch_scc1 L_chk1
L_go1:
    v_max_f32_dpp v64, v136, v136 row_ror:8 row_mask:0xf bank_mask:0xf
    v_mov_b32 v65, v64
    s_nop 1
    v_permlane16_swap_b32 v64, v65
    v_max_f32 v64, v64, v65
    v_mov_b32 v65, v64
    s_nop 1
    v_permlane32_swap_b32 v64, v65
    v_max_f32 v64, v64, v65
    v_sub_f32 v64, v136, v64
    v_exp_f32 v64, v64
    s_nop 0
    v_mul_f32 v66, v64, v137
    v_mul_f32 v128, v64, v128
    v_mul_f32 v129, v64, v129
    v_mul_f32 v130, v64, v130
    v_mul_f32 v131, v64, v131
    v_mul_f32 v132, v64, v132
    v_mul_f32 v133, v64, v133
    v_mul_f32 v134, v64, v134
    v_mul_f32 v135, v64, v135
    v_add_f32_dpp v66, v66, v66 row_ror:8 row_mask:0xf bank_mask:0xf
    v_permlane32_swap_b32 v128, v132
    v_permlane32_swap_b32 v129, v133
    v_permlane32_swap_b32 v130, v134
    v_permlane32_swap_b32 v131, v135
    v_mov_b32 v65, v66
    s_nop 1
    v_permlane16_swap_b32 v66, v65
    v_add_f32 v66, v66, v65
    v_add_f32 v128, v128, v132
    v_add_f32 v129, v129, v133
    v_add_f32 v130, v130, v134
    v_add_f32 v131, v131, v135
    v_mov_b32 v65, v66
    s_nop 1
    v_permlane32_swap_b32 v66, v65
    v_add_f32 v66, v66, v65
    v_permlane16_swap_b32 v128, v130
    v_permlane16_swap_b32 v129, v131
    v_rcp_f32 v66, v66
    v_add_f32 v128, v128, v130
    v_add_f32 v129, v129, v131
    s_nop 0
    v_add_f32_dpp v128, v128, v128 row_ror:8 row_mask:0xf bank_mask:0xf
    v_add_f32_dpp v129, v129, v129 row_ror:8 row_mask:0xf bank_mask:0xf
    v_mul_f32 v128, v128, v66
    v_mul_f32 v129, v129, v66
    v_cvt_pk_bf16_f32 v128, v128, v128
    v_cvt_pk_bf16_f32 v129, v129, v129
    ds_write_b64 v23, v[128:129] offset:3392
    s_waitcnt lgkmcnt(0)
L_b3b:
    s_barrier
    s_cmp_ge_u32 s65, 2048
    s_cbranch_scc1 L_fin
    ds_read_b64 v[128:129], v7 offset:3392
    ds_read_b64 v[130:131], v7 offset:3400
    ds_read_b64 v[132:133], v7 offset:3408
    s_waitcnt lgkmcnt(0)
    v_and_b32 v64, v52, v128
    v_and_b32 v65, v53, v128
    v_and_b32 v66, v54, v128
    v_and_b32 v67, v55, v128
    v_and_b32 v68, v52, v129
    v_and_b32 v69, v53, v129
    v_and_b32 v70, v54, v129
    v_and_b32 v71, v55, v129
    v_mfma_f32_16x16x32_bf16 v[124:127], v[64:67], v[92:95], v[124:127]
    v_and_b32 v72, v52, v130
    v_and_b32 v73, v53, v130
    v_and_b32 v74, v54, v130
    v_and_b32 v75, v55, v130
    v_mfma_f32_16x16x32_bf16 v[124:127], v[68:71], v[96:99], v[124:127]
    v_and_b32 v76, v52, v131
    v_and_b32 v77, v53, v131
    v_and_b32 v78, v54, v131
    v_and_b32 v79, v55, v131
    v_mfma_f32_16x16x32_bf16 v[124:127], v[72:75], v[100:103], v[124:127]
    v_and_b32 v80, v52, v132
    v_and_b32 v81, v53, v132
    v_and_b32 v82, v54, v132
    v_and_b32 v83, v55, v132
    v_mfma_f32_16x16x32_bf16 v[124:127], v[76:79], v[104:107], v[124:127]
    v_and_b32 v84, v52, v133
    v_and_b32 v85, v53, v133
    v_and_b32 v86, v54, v133
    v_and_b32 v87, v55, v133
    v_mfma_f32_16x16x32_bf16 v[124:127], v[80:83], v[108:111], v[124:127]
    s_nop 0
    v_mfma_f32_16x16x32_bf16 v[124:127], v[84:87], v[112:115], v[124:127]
    s_nop 7
    v_mov_b32 v20, v124
    v_mov_b32 v21, v125
    v_mov_b32 v22, v126
    v_mov_b32 v23, v127
    v_permlane32_swap_b32 v124, v20
    v_permlane32_swap_b32 v125, v21
    v_permlane32_swap_b32 v126, v22
    v_permlane32_swap_b32 v127, v23
    v_add_f32_dpp v24, v20, v124 row_ror:8 row_mask:0xf bank_mask:0xf
    v_add_f32_dpp v25, v21, v125 row_ror:8 row_mask:0xf bank_mask:0xf
    v_add_f32_dpp v26, v22, v126 row_ror:8 row_mask:0xf bank_mask:0xf
    v_add_f32_dpp v27, v23, v127 row_ror:8 row_mask:0xf bank_mask:0xf
    v_or_b32 v24, 1, v24
    v_or_b32 v25, 1, v25
    v_or_b32 v26, 1, v26
    v_or_b32 v27, 1, v27
    s_mov_b64 exec, 0x00ff00ff
    buffer_store_dwordx4 v[24:27], v11, s[16:19], s58 offen sc1
    s_mov_b64 exec, -1
    s_nop 0
    s_branch L_fin
L_w0:
    v_mov_b32 v65, 0
    v_mul_u32_u24 v66, 43, v2
    v_lshrrev_b32 v66, 9, v66
    v_mul_u32_u24 v67, 12, v66
    v_sub_u32 v67, v2, v67
    v_lshlrev_b32 v66, 11, v66
    v_lshl_add_u32 v66, v67, 4, v66
    v_subrev_u32 v67, 48, v2
    v_lshlrev_b32 v67, 11, v67
    v_add_u32 v67, 192, v67
    v_cmp_gt_u32 vcc, 48, v2
    s_nop 1
    v_cndmask_b32 v66, v67, v66, vcc
    s_mov_b32 s62, 0
    s_mov_b32 s63, 0xffff0000
    s_waitcnt lgkmcnt(0)
    s_barrier
    ds_read_b128 v[20:23], v65 offset:3584
    ds_read_b128 v[24:27], v65 offset:3600
    ds_read_b128 v[28:31], v65 offset:3616
    ds_read_b128 v[32:35], v65 offset:3632
    ds_read_b128 v[148:151], v6 offset:3712
    ds_read_b128 v[152:155], v6 offset:4480
    ds_read_b128 v[156:159], v6 offset:5248
    ds_read_b128 v[160:163], v6 offset:6016
    ds_read_b128 v[164:167], v6 offset:6784
    ds_read_b128 v[168:171], v6 offset:7552
    ds_read_b128 v[172:175], v6 offset:8320
    ds_read_b128 v[176:179], v6 offset:9088
    ds_read_b128 v[180:183], v6 offset:9856
    ds_read_b128 v[184:187], v6 offset:10624
    s_waitcnt lgkmcnt(9)
    ds_read_b128 v[188:191], v6 offset:11392
    ds_read_b128 v[192:195], v6 offset:12160
    ds_read_b128 v[196:199], v6 offset:12928
    ds_read_b128 v[200:203], v6 offset:13696
    ds_read_b128 v[204:207], v6 offset:14464
    ds_read_b128 v[208:211], v6 offset:15232
    v_max3_f32 v68, v20, v22, v24
    v_max3_f32 v68, v68, v26, v28
    v_max3_f32 v68, v68, v30, v32
    v_max_f32 v68, v68, v34
    v_sub_f32 v20, v20, v68
    v_sub_f32 v22, v22, v68
    v_sub_f32 v24, v24, v68
    v_sub_f32 v26, v26, v68
    v_sub_f32 v28, v28, v68
    v_sub_f32 v30, v30, v68
    v_sub_f32 v32, v32, v68
    v_sub_f32 v34, v34, v68
    v_exp_f32 v20, v20
    v_exp_f32 v22, v22
    v_exp_f32 v24, v24
    v_exp_f32 v26, v26
    v_exp_f32 v28, v28
    v_exp_f32 v30, v30
    v_exp_f32 v32, v32
    v_exp_f32 v34, v34
    v_mul_f32 v69, v20, v21
    v_fmac_f32 v69, v22, v23
    v_fmac_f32 v69, v24, v25
    v_fmac_f32 v69, v26, v27
    v_fmac_f32 v69, v28, v29
    v_fmac_f32 v69, v30, v31
    v_fmac_f32 v69, v32, v33
    v_fmac_f32 v69, v34, v35
    s_waitcnt lgkmcnt(0)
    v_pk_add_f32 v[148:149], v[148:149], v[152:153]
    v_pk_add_f32 v[150:151], v[150:151], v[154:155]
    v_pk_add_f32 v[156:157], v[156:157], v[160:161]
    v_pk_add_f32 v[158:159], v[158:159], v[162:163]
    v_pk_add_f32 v[164:165], v[164:165], v[168:169]
    v_pk_add_f32 v[166:167], v[166:167], v[170:171]
    v_pk_add_f32 v[172:173], v[172:173], v[176:177]
    v_pk_add_f32 v[174:175], v[174:175], v[178:179]
    v_pk_add_f32 v[180:181], v[180:181], v[184:185]
    v_pk_add_f32 v[182:183], v[182:183], v[186:187]
    v_pk_add_f32 v[188:189], v[188:189], v[192:193]
    v_pk_add_f32 v[190:191], v[190:191], v[194:195]
    v_pk_add_f32 v[196:197], v[196:197], v[200:201]
    v_pk_add_f32 v[198:199], v[198:199], v[202:203]
    v_pk_add_f32 v[204:205], v[204:205], v[208:209]
    v_pk_add_f32 v[206:207], v[206:207], v[210:211]
    v_mul_f32 v72, v20, v148
    v_mul_f32 v73, v20, v149
    v_mul_f32 v74, v20, v150
    v_mul_f32 v75, v20, v151
    v_fmac_f32 v72, v22, v156
    v_fmac_f32 v73, v22, v157
    v_fmac_f32 v74, v22, v158
    v_fmac_f32 v75, v22, v159
    v_fmac_f32 v72, v24, v164
    v_fmac_f32 v73, v24, v165
    v_fmac_f32 v74, v24, v166
    v_fmac_f32 v75, v24, v167
    v_fmac_f32 v72, v26, v172
    v_fmac_f32 v73, v26, v173
    v_fmac_f32 v74, v26, v174
    v_fmac_f32 v75, v26, v175
    v_fmac_f32 v72, v28, v180
    v_fmac_f32 v73, v28, v181
    v_fmac_f32 v74, v28, v182
    v_fmac_f32 v75, v28, v183
    v_fmac_f32 v72, v30, v188
    v_fmac_f32 v73, v30, v189
    v_fmac_f32 v74, v30, v190
    v_fmac_f32 v75, v30, v191
    v_fmac_f32 v72, v32, v196
    v_fmac_f32 v73, v32, v197
    v_fmac_f32 v74, v32, v198
    v_fmac_f32 v75, v32, v199
    v_fmac_f32 v72, v34, v204
    v_fmac_f32 v73, v34, v205
    v_fmac_f32 v74, v34, v206
    v_fmac_f32 v75, v34, v207
    v_cndmask_b32 v72, v72, v68, s[62:63]
    v_cndmask_b32 v73, v73, v69, s[62:63]
    v_cndmask_b32 v74, v74, v68, s[62:63]
    v_cndmask_b32 v75, v75, v69, s[62:63]
    v_min_u32 v72, -2, v72
    v_min_u32 v73, -2, v73
    v_min_u32 v74, -2, v74
    v_min_u32 v75, -2, v75
    s_mov_b32 exec_lo, -1
    s_mov_b32 exec_hi, 0xfffff
    s_cmp_eq_u32 s66, 2
    s_cbranch_scc1 L_h1L
    buffer_store_dwordx4 v[72:75], v66, s[16:19], s56 offen sc1
    s_mov_b64 exec, -1
    s_nop 0
    s_branch L_b3b
L_h1L:
    buffer_store_dwordx4 v[72:75], v66, s[16:19], s56 offen
    s_mov_b64 exec, -1
    s_nop 0
    s_branch L_b3b
L_fin:
    s_cmp_ge_u32 s2, 20
    s_cbranch_scc1 L_done
    v_lshrrev_b32 v15, 3, v0
    v_mul_u32_u24 v15, 2560, v15
    v_add_u32 v15, v15, v3
    s_lshl_b32 s62, s2, 7
    s_add_u32 s62, s62, 2097152
    s_add_u32 s61, s62, 163840
    v_lshlrev_b32 v16, 2, v2
    s_lshl_b32 s60, s2, 6
    buffer_load_dword v17, v16, s[40:43], s60 offen
    s_mov_b32 s63, 1048576
    buffer_load_dwordx4 v[72:75], v15, s[16:19], s62 offen sc1
    buffer_load_dwordx4 v[76:79], v15, s[16:19], s61 offen sc1
L_poll2:
    s_waitcnt vmcnt(0)
    v_and_b32 v18, v72, v73
    v_and_b32 v19, v74, v75
    v_and_b32 v20, v76, v77
    v_and_b32 v21, v78, v79
    v_and_b32 v18, v18, v19
    v_and_b32 v20, v20, v21
    v_and_b32 v18, v18, v20
    v_and_b32 v18, 1, v18
    v_add_f32 v64, v72, v76
    v_add_f32 v65, v73, v77
    v_add_f32 v66, v74, v78
    v_add_f32 v67, v75, v79
    v_cmp_eq_u32 vcc, 0, v18
    s_cmp_eq_u64 vcc, 0
    s_nop 3
    s_cbranch_scc1 L_go2
    buffer_load_dwordx4 v[72:75], v15, s[16:19], s62 offen sc1
    buffer_load_dwordx4 v[76:79], v15, s[16:19], s61 offen sc1
    s_sub_u32 s63, s63, 1
    s_cmp_lg_u32 s63, 0
    s_cbranch_scc1 L_poll2
L_go2:
    v_permlane32_swap_b32 v64, v66
    v_permlane32_swap_b32 v65, v67
    v_add_f32 v64, v64, v66
    v_add_f32 v65, v65, v67
    s_nop 1
    v_permlane16_swap_b32 v64, v65
    v_add_f32 v64, v64, v65
    s_nop 1
    v_add_f32_dpp v64, v64, v64 row_ror:8 row_mask:0xf bank_mask:0xf
    v_lshrrev_b32 v18, 4, v2
    v_lshlrev_b32 v18, 2, v18
    s_lshl_b32 s62, s3, 7
    v_add3_u32 v18, v18, v3, s62
    ds_write_b32 v18, v64 offset:16256
    s_waitcnt lgkmcnt(0)
    s_barrier
    s_cmp_lg_u32 s3, 0
    s_cbranch_scc1 L_done
    s_mov_b64 exec, 0xffff
    v_lshlrev_b32 v18, 3, v2
    ds_read_b64 v[160:161], v18 offset:16256
    ds_read_b64 v[162:163], v18 offset:16384
    ds_read_b64 v[164:165], v18 offset:16512
    ds_read_b64 v[166:167], v18 offset:16640
    ds_read_b64 v[168:169], v18 offset:16768
    ds_read_b64 v[170:171], v18 offset:16896
    ds_read_b64 v[172:173], v18 offset:17024
    ds_read_b64 v[174:175], v18 offset:17152
    v_lshlrev_b32 v64, 16, v17
    v_and_b32 v65, 0xffff0000, v17
    s_waitcnt lgkmcnt(0)
    v_add_f32 v64, v64, v160
    v_add_f32 v65, v65, v161
    v_add_f32 v64, v64, v162
    v_add_f32 v65, v65, v163
    v_add_f32 v64, v64, v164
    v_add_f32 v65, v65, v165
    v_add_f32 v64, v64, v166
    v_add_f32 v65, v65, v167
    v_add_f32 v64, v64, v168
    v_add_f32 v65, v65, v169
    v_add_f32 v64, v64, v170
    v_add_f32 v65, v65, v171
    v_add_f32 v64, v64, v172
    v_add_f32 v65, v65, v173
    v_add_f32 v64, v64, v174
    v_add_f32 v65, v65, v175
    v_cvt_pk_bf16_f32 v64, v64, v65
    buffer_store_dword v64, v16, s[44:47], s60 offen
    s_mov_b64 exec, -1
L_done:
L_end:
    s_endpgm
.section .rodata,"a"
.p2align 6
.amdhsa_kernel parallel_sum__sliding_block_cached__glu_gated_swiglu__decode_kernel
  .amdhsa_next_free_vgpr 256
  .amdhsa_next_free_sgpr 102
  .amdhsa_accum_offset 256
  .amdhsa_group_segment_fixed_size 0
  .amdhsa_kernarg_size 96
  .amdhsa_user_sgpr_count 2
  .amdhsa_user_sgpr_kernarg_segment_ptr 1
  .amdhsa_system_sgpr_workgroup_id_x 1
.end_amdhsa_kernel
```
